```python
import torch

def _softmax(x, axis=-1):
    return torch.softmax(x, dim=axis)
def _gelu(x):
    return torch.nn.functional.gelu(x, approximate="tanh")
def _silu(x):
    return torch.nn.functional.silu(x)
def _sigmoid(x):
    return torch.sigmoid(x)
def _layernorm(x, axis=-1, eps=1e-5):
    m = x.mean(dim=axis, keepdim=True)
    v = x.var(dim=axis, keepdim=True, unbiased=False)
    return (x - m) / torch.sqrt(v + eps)
def _scatter_add(tgt, idx, src, axis=0):
    return tgt.clone().index_add_(axis, idx, src)
def _segment_sum(src, seg, n):
    out = torch.zeros((n,) + src.shape[1:], dtype=src.dtype)
    return out.index_add_(0, seg, src)
def _pad(x, pw):
    flat = tuple(v for pair in reversed(pw) for v in pair)
    return torch.nn.functional.pad(x, flat)

kernel_name = 'interleave_layers__sliding_block_cached__dense_activation_mish__decode'

def setup_inputs():

    _w = (lambda a: (lambda t: t.to(torch.bfloat16) if t.is_floating_point() else t)(torch.as_tensor(a)))
    def _A_setup():
        B, Sq, D = 1, 1, 640
        Hq, Hkv, Sk, Dh = 32, 32, 8192, 192
        assert Hq % Hkv == 0, (Hq, Hkv)
        return {
            "x": _w((lambda *s: torch.randn(*s, dtype=torch.bfloat16) * 0.1)(B, Sq, D)),
            "k_cache": _w((lambda *s: torch.randn(*s, dtype=torch.bfloat16) * 0.8)(B, Hkv, Sk, Dh)),
            "v_cache": _w((lambda *s: torch.randn(*s, dtype=torch.bfloat16) * 3.2)(B, Hkv, Sk, Dh)),
            "wq": _w((lambda *s: torch.randn(*s, dtype=torch.bfloat16) * 0.8)(D, Hq * Dh) * (D ** -0.5)),
            "wo": _w((lambda *s: torch.randn(*s, dtype=torch.bfloat16) * 3.2)(Hq * Dh, D) * ((Hq * Dh) ** -0.5)),
        }
    _A_in = _A_setup()

    def _B_setup():
        B, S, D, F = 1, 1, 640, 1536
        return {
            "x": _w((lambda *s: torch.randn(*s, dtype=torch.bfloat16) * 0.1)(B, S, D)),
            "w1": _w((lambda *s: torch.randn(*s, dtype=torch.bfloat16) * 1.6)(D, F) * (D ** -0.5)),
            "b1": _w((lambda *s: torch.randn(*s, dtype=torch.bfloat16) * 0.4)(F)),
            "w2": _w((lambda *s: torch.randn(*s, dtype=torch.bfloat16) * 0.4)(F, D) * (F ** -0.5)),
        }
    _B_in = _B_setup()

    return {
        "A_x": _A_in["x"],
        "A_k_cache": _A_in["k_cache"],
        "A_v_cache": _A_in["v_cache"],
        "A_wq": _A_in["wq"],
        "A_wo": _A_in["wo"],
        "B_x": _B_in["x"],
        "B_w1": _B_in["w1"],
        "B_b1": _B_in["b1"],
        "B_w2": _B_in["w2"],
    }

def reference(A_x, A_k_cache, A_v_cache, A_wq, A_wo, B_x, B_w1, B_b1, B_w2):
    def _A_ref(x, k_cache, v_cache, wq, wo):
        B, Sq, D = x.shape
        Hq, Dh = 32, 192
        Hkv, Sk = k_cache.shape[1], k_cache.shape[2]
        W = min(4096, max(256, Sk // 4))
        rep = Hq // Hkv
        q = (lambda x, *d: x.permute(*d))((x @ wq).reshape(B, Sq, Hq, Dh), 0, 2, 1, 3)
        k = (lambda x, n, axis: torch.repeat_interleave(x, n, dim=axis))(k_cache[:, :, Sk - W:, :], rep, axis=1)
        v = (lambda x, n, axis: torch.repeat_interleave(x, n, dim=axis))(v_cache[:, :, Sk - W:, :], rep, axis=1)
        scores = torch.einsum("bhqd,bhkd->bhqk", q, k) * (Dh ** -0.5)
        p = _softmax(scores, axis=-1)
        o = torch.einsum("bhqk,bhkd->bhqd", p, v)
        return (lambda x, *d: x.permute(*d))(o, 0, 2, 1, 3).reshape(B, Sq, Hq * Dh) @ wo

    def _B_ref(x, w1, b1, w2):
        h = torch.einsum("bsd,df->bsf", x, w1) + b1
        sp = torch.log1p(torch.exp(-torch.abs(h))) + torch.where(h > 0, h, torch.zeros_like(h))
        act = h * torch.tanh(sp)
        return torch.einsum("bsf,fd->bsd", act, w2)

    x = A_x
    x = x + _A_ref(_layernorm(x, axis=-1), A_k_cache, A_v_cache, A_wq, A_wo)
    x = x + _B_ref(_layernorm(x, axis=-1), B_w1, B_b1, B_w2)
    x = x + _A_ref(_layernorm(x, axis=-1), A_k_cache, A_v_cache, A_wq, A_wo)
    x = x + _B_ref(_layernorm(x, axis=-1), B_w1, B_b1, B_w2)
    return x
```

```asm
; @launch grid=(256,1,1) block=(512,1,1) lds=138752
.amdgcn_target "amdgcn-amd-amdhsa--gfx950"
.text
.globl interleave_layers__sliding_block_cached__dense_activation_mish__decode_kernel
.p2align 8
.type interleave_layers__sliding_block_cached__dense_activation_mish__decode_kernel,@function
interleave_layers__sliding_block_cached__dense_activation_mish__decode_kernel:
    s_cmp_ge_u32 s2, 256
    s_cbranch_scc1 L_end
    s_load_dwordx2 s[12:13], s[0:1], 8
    s_load_dwordx2 s[20:21], s[0:1], 24
    s_load_dwordx2 s[8:9], s[0:1], 0
    s_load_dwordx2 s[48:49], s[0:1], 88
    s_load_dwordx2 s[16:17], s[0:1], 16
    s_load_dwordx2 s[24:25], s[0:1], 32
    s_load_dwordx2 s[28:29], s[0:1], 48
    s_load_dwordx2 s[32:33], s[0:1], 56
    s_load_dwordx2 s[36:37], s[0:1], 64
    s_load_dwordx2 s[40:41], s[0:1], 72
    v_lshrrev_b32 v1, 6, v0
    v_and_b32 v0, 63, v0
    v_readfirstlane_b32 s3, v1
    s_getpc_b64 s[72:73]
L_pcref0:
    s_sub_u32 s72, s72, L_pcref0-interleave_layers__sliding_block_cached__dense_activation_mish__decode_kernel
    s_subb_u32 s73, s73, 0
    s_and_b32 s58, s2, 0xf8
    s_add_u32 s58, s58, s3
    s_lshl_b32 s58, s58, 7
    s_cmp_ge_u32 s58, L_end-interleave_layers__sliding_block_cached__dense_activation_mish__decode_kernel
    s_cbranch_scc1 L_nocpf0
    v_mov_b32 v2, s58
    s_mov_b64 exec, 1
    global_load_dword v223, v2, s[72:73]
    s_mov_b64 exec, -1
L_nocpf0:
    s_and_b32 s4, s2, 7
    s_lshr_b32 s5, s2, 3
    s_lshr_b32 s6, s5, 3
    s_and_b32 s7, s5, 7
    v_and_b32 v1, 7, v0
    v_lshrrev_b32 v2, 3, v0
    v_lshrrev_b32 v3, 4, v0
    v_lshlrev_b32 v76, 2, v0
    s_cmp_ge_u32 s3, 4
    s_cbranch_scc1 L_pro_v
    s_setprio 3
    s_mov_b32 s71, 1212416
    s_cmp_eq_u32 s3, 3
    s_cbranch_scc1 L_pro_c
    s_mov_b32 s10, 1280
    s_mov_b32 s11, 0x20000
    s_mov_b32 s22, 7864320
    s_mov_b32 s23, 0x20000
    v_lshlrev_b32 v83, 4, v0
    v_and_b32 v84, 15, v0
    v_lshlrev_b32 v84, 7, v84
    v_lshl_add_u32 v84, v3, 2, v84
    s_lshl_b32 s61, s7, 4
    v_bfe_u32 v85, v0, 3, 1
    v_lshrrev_b32 v86, 5, v0
    v_lshl_add_u32 v85, v86, 1, v85
    v_bfe_u32 v86, v0, 4, 1
    v_lshl_add_u32 v85, v86, 6, v85
    v_mul_u32_u24 v85, 12288, v85
    v_lshl_add_u32 v85, v1, 4, v85
    s_lshl_b32 s58, s4, 2
    s_add_u32 s58, s58, s6
    s_mul_i32 s58, s58, 384
    s_lshl_b32 s60, s3, 7
    s_add_u32 s58, s58, s60
    s_mul_i32 s60, s7, 98304
    s_add_u32 s58, s58, s60
    s_waitcnt lgkmcnt(0)
    buffer_load_dwordx4 v[36:39], v83, s[8:11], 0 offen
    buffer_load_dword v40, v76, s[8:11], 0 offen offset:1024
    buffer_load_dword v60, v84, s[8:11], s61 offen
    buffer_load_dwordx4 v[184:187], v85, s[20:23], s58 offen nt
    s_add_u32 s58, s58, 49152
    buffer_load_dwordx4 v[188:191], v85, s[20:23], s58 offen nt
    s_add_u32 s58, s58, 1523712
    buffer_load_dwordx4 v[192:195], v85, s[20:23], s58 offen nt
    s_add_u32 s58, s58, 49152
    buffer_load_dwordx4 v[196:199], v85, s[20:23], s58 offen nt
    s_add_u32 s58, s58, 1523712
    buffer_load_dwordx4 v[200:203], v85, s[20:23], s58 offen nt
    s_add_u32 s58, s58, 49152
    buffer_load_dwordx4 v[204:207], v85, s[20:23], s58 offen nt
    s_add_u32 s58, s58, 1523712
    buffer_load_dwordx4 v[208:211], v85, s[20:23], s58 offen nt
    s_add_u32 s58, s58, 49152
    buffer_load_dwordx4 v[212:215], v85, s[20:23], s58 offen nt
    s_add_u32 s58, s58, 1523712
    buffer_load_dwordx4 v[216:219], v85, s[20:23], s58 offen nt
    s_add_u32 s58, s58, 49152
    buffer_load_dwordx4 v[220:223], v85, s[20:23], s58 offen nt
    s_barrier
    s_branch L_k_rest
L_pro_c:
    s_mov_b32 s10, 1280
    s_mov_b32 s11, 0x20000
    s_mov_b32 s50, 1224704
    s_mov_b32 s51, 0x20000
    s_mul_i32 s53, s4, 151552
    s_mul_i32 s52, s5, 4736
    s_add_u32 s52, s52, s53
    s_cmp_ge_u32 s5, 10
    s_cselect_b32 s57, 1, 0
    s_cmp_ge_u32 s5, 20
    s_cselect_b32 s57, 2, s57
    s_cmp_ge_u32 s5, 30
    s_cselect_b32 s57, 3, s57
    s_mul_i32 s56, s57, 10
    s_sub_u32 s56, s5, s56
    v_lshlrev_b32 v71, 4, v1
    v_lshl_add_u32 v71, v3, 2, v71
    v_mov_b32 v83, 0
    s_mov_b64 exec, 0xffff
    ds_write_b32 v76, v83 offset:0
    s_mov_b64 exec, -1
    s_waitcnt lgkmcnt(0)
    s_barrier
    v_mov_b32 v64, -1
    v_mov_b32 v65, -1
    v_mov_b32 v66, -1
    v_mov_b32 v67, -1
    v_lshlrev_b32 v86, 4, v0
    s_mov_b32 exec_hi, 0
    buffer_store_dwordx4 v[64:67], v86, s[48:51], s52 offen sc1
    s_mov_b32 exec_lo, 0xffff
    buffer_store_dwordx4 v[64:67], v86, s[48:51], s52 offen offset:2560
    s_mov_b64 exec, -1
    buffer_store_dwordx4 v[64:67], v86, s[48:51], s52 offen offset:512
    buffer_store_dwordx4 v[64:67], v86, s[48:51], s52 offen offset:1536
    s_lshl_b32 s58, s56, 7
    buffer_load_dword v40, v71, s[8:11], s58 offen
    s_branch L_c_rest
L_pro_v:
    s_mov_b32 s14, 100663296
    s_mov_b32 s15, 0x20000
    s_mov_b32 s18, 100663296
    s_mov_b32 s19, 0x20000
    s_lshl_b32 s58, s4, 2
    s_add_u32 s58, s58, s6
    s_mul_i32 s59, s58, 3145728
    s_lshl_b32 s58, s7, 8
    s_and_b32 s60, s3, 3
    s_lshl_b32 s60, s60, 6
    s_add_u32 s58, s58, s60
    s_add_u32 s58, s58, 6144
    s_mul_i32 s58, s58, 384
    s_add_u32 s59, s59, s58
    v_lshrrev_b32 v83, 3, v0
    v_and_b32 v84, 6, v83
    v_xor_b32 v84, v84, v0
    v_and_b32 v84, 7, v84
    v_mul_u32_u24 v83, 384, v83
    v_lshl_add_u32 v83, v84, 4, v83
    s_and_b32 s60, s3, 3
    s_mul_i32 s60, s60, 24576
    s_add_u32 s60, s60, 8192
    s_mov_b32 s58, s59
    s_add_u32 s61, s59, 24576
    v_mul_u32_u24 v87, 384, v2
    v_lshl_add_u32 v87, v1, 4, v87
    s_waitcnt lgkmcnt(0)
    s_barrier
    s_add_u32 s62, s59, 0
L_kdma:
    s_add_u32 m0, s60, 0
    s_nop 0
    buffer_load_dwordx4 v83, s[12:15], s58 offen offset:0 nt lds
    s_add_u32 m0, s60, 896
    s_nop 0
    buffer_load_dwordx4 v83, s[12:15], s58 offen offset:128 nt lds
    s_add_u32 m0, s60, 1792
    s_nop 0
    buffer_load_dwordx4 v83, s[12:15], s58 offen offset:256 nt lds
    s_add_u32 s60, s60, 3072
    s_add_u32 s58, s58, 3072
    s_cmp_lt_u32 s58, s61
    s_cbranch_scc1 L_kdma
    s_add_u32 s58, s59, 0
    buffer_load_dwordx4 v[88:91], v87, s[16:19], s58 offen offset:0 nt
    buffer_load_dwordx4 v[96:99], v87, s[16:19], s58 offen offset:128 nt
    buffer_load_dwordx4 v[104:107], v87, s[16:19], s58 offen offset:256 nt
    s_add_u32 s58, s59, 3072
    buffer_load_dwordx4 v[92:95], v87, s[16:19], s58 offen offset:0 nt
    buffer_load_dwordx4 v[100:103], v87, s[16:19], s58 offen offset:128 nt
    buffer_load_dwordx4 v[108:111], v87, s[16:19], s58 offen offset:256 nt
    s_add_u32 s58, s59, 6144
    buffer_load_dwordx4 v[112:115], v87, s[16:19], s58 offen offset:0 nt
    buffer_load_dwordx4 v[120:123], v87, s[16:19], s58 offen offset:128 nt
    s_lshl_b32 s60, s3, 2
    v_mov_b32 v85, s60
    v_mov_b32 v86, 1
    s_waitcnt vmcnt(8)
    ds_write_b32 v85, v86 offset:0
    buffer_load_dwordx4 v[128:131], v87, s[16:19], s58 offen offset:256 nt
    s_add_u32 s58, s59, 9216
    buffer_load_dwordx4 v[116:119], v87, s[16:19], s58 offen offset:0 nt
    buffer_load_dwordx4 v[124:127], v87, s[16:19], s58 offen offset:128 nt
    buffer_load_dwordx4 v[132:135], v87, s[16:19], s58 offen offset:256 nt
    s_add_u32 s58, s59, 12288
    buffer_load_dwordx4 v[136:139], v87, s[16:19], s58 offen offset:0 nt
    buffer_load_dwordx4 v[144:147], v87, s[16:19], s58 offen offset:128 nt
    buffer_load_dwordx4 v[152:155], v87, s[16:19], s58 offen offset:256 nt
    s_add_u32 s58, s59, 15360
    buffer_load_dwordx4 v[140:143], v87, s[16:19], s58 offen offset:0 nt
    buffer_load_dwordx4 v[148:151], v87, s[16:19], s58 offen offset:128 nt
    buffer_load_dwordx4 v[156:159], v87, s[16:19], s58 offen offset:256 nt
    s_add_u32 s58, s59, 18432
    buffer_load_dwordx4 v[160:163], v87, s[16:19], s58 offen offset:0 nt
    buffer_load_dwordx4 v[168:171], v87, s[16:19], s58 offen offset:128 nt
    buffer_load_dwordx4 v[176:179], v87, s[16:19], s58 offen offset:256 nt
    s_add_u32 s58, s59, 21504
    buffer_load_dwordx4 v[164:167], v87, s[16:19], s58 offen offset:0 nt
    buffer_load_dwordx4 v[172:175], v87, s[16:19], s58 offen offset:128 nt
    buffer_load_dwordx4 v[180:183], v87, s[16:19], s58 offen offset:256 nt
    s_mov_b32 s10, 1280
    s_mov_b32 s11, 0x20000
    s_mov_b32 s22, 7864320
    s_mov_b32 s23, 0x20000
    s_mov_b32 s26, 7864320
    s_mov_b32 s27, 0x20000
    s_mov_b32 s30, 1966080
    s_mov_b32 s31, 0x20000
    s_mov_b32 s34, 3072
    s_mov_b32 s35, 0x20000
    s_mov_b32 s38, 1966080
    s_mov_b32 s39, 0x20000
    s_mov_b32 s42, 1280
    s_mov_b32 s43, 0x20000
    s_mov_b32 s50, 1224704
    s_mov_b32 s51, 0x20000
    s_mul_i32 s53, s4, 151552
    s_mul_i32 s52, s5, 4736
    s_add_u32 s52, s52, s53
    s_cmp_ge_u32 s5, 10
    s_cselect_b32 s57, 1, 0
    s_cmp_ge_u32 s5, 20
    s_cselect_b32 s57, 2, s57
    s_cmp_ge_u32 s5, 30
    s_cselect_b32 s57, 3, s57
    s_mul_i32 s56, s57, 10
    s_sub_u32 s56, s5, s56
    v_lshlrev_b32 v71, 4, v1
    v_lshl_add_u32 v71, v3, 2, v71
    s_mov_b32 s54, 0
    s_mov_b32 s55, 0
    s_getreg_b32 s75, hwreg(HW_REG_XCC_ID)
    s_and_b32 s75, s75, 15
    s_mov_b32 s64, 0x00ff00ff
    s_mov_b32 s65, 0x00ff00ff
    s_mov_b32 s66, 0xaaaaaaaa
    s_mov_b32 s67, 0xaaaaaaaa
    s_mov_b32 s68, 0xcccccccc
    s_mov_b32 s69, 0xcccccccc
    s_mov_b32 s44, 0x03ff03ff
    s_mov_b32 s45, 0x03ff03ff
    s_mov_b32 s46, 1
    s_mov_b32 s47, 1
    v_and_b32 v83, 1, v0
    v_mul_u32_u24 v83, 0x202, v83
    v_add_u32 v83, 0x100, v83
    v_bfe_u32 v84, v0, 1, 1
    v_lshlrev_b32 v84, 4, v84
    v_lshlrev_b32 v83, v84, v83
    v_mov_b32 v85, 0x0c0c0000
    v_lshrrev_b32 v85, v84, v85
    v_or_b32 v83, v83, v85
    v_bfe_u32 v84, v0, 2, 2
    v_mov_b32 v85, 0x0c0c0c0c
    v_cmp_eq_u32 vcc, 0, v84
    s_nop 1
    v_cndmask_b32 v8, v85, v83, vcc
    v_cmp_eq_u32 vcc, 1, v84
    s_nop 1
    v_cndmask_b32 v9, v85, v83, vcc
    v_cmp_eq_u32 vcc, 2, v84
    s_nop 1
    v_cndmask_b32 v10, v85, v83, vcc
    v_cmp_eq_u32 vcc, 3, v84
    s_nop 1
    v_cndmask_b32 v11, v85, v83, vcc
    v_mov_b32 v83, 0x3f803f80
    v_perm_b32 v4, v83, v83, v8
    v_perm_b32 v5, v83, v83, v9
    v_perm_b32 v6, v83, v83, v10
    v_perm_b32 v7, v83, v83, v11
    v_and_b32 v83, 1, v0
    v_lshlrev_b32 v83, 4, v83
    v_mov_b32 v84, 0xffff
    v_lshlrev_b32 v83, v83, v84
    v_and_b32 v84, 8, v0
    v_cmp_eq_u32 vcc, 0, v84
    v_mov_b32 v85, 0
    s_nop 0
    v_cndmask_b32 v56, v85, v83, vcc
    v_cndmask_b32 v57, v83, v85, vcc
    v_mov_b32 v83, 0x4444
    v_mov_b32 v84, 0xeeee
    v_cndmask_b32 v59, v84, v83, vcc
    v_bfe_u32 v83, v0, 1, 2
    v_mul_u32_u24 v58, 0x5555, v83
    v_and_b32 v1, 7, v0
    v_lshrrev_b32 v2, 3, v0
    v_lshrrev_b32 v3, 4, v0
    s_min_u32 s61, s57, 2
    s_lshl_b32 s58, s61, 2
    s_and_b32 s60, s3, 3
    s_add_u32 s58, s58, s60
    s_mul_i32 s60, s58, 43
    s_lshr_b32 s60, s60, 7
    s_mul_i32 s61, s60, 3
    s_sub_u32 s58, s58, s61
    s_mul_i32 s60, s60, 37888
    s_add_u32 s60, s60, s53
    s_lshl_b32 s58, s58, 7
    s_add_u32 s58, s58, s60
    v_mul_u32_u24 v70, 4736, v2
    v_lshl_add_u32 v70, v1, 4, v70
    v_add_u32 v70, s58, v70
    v_lshl_add_u32 v73, v3, 1, v0
    v_and_b32 v73, 7, v73
    v_lshlrev_b32 v73, 3, v73
    v_add_u32 v73, s60, v73
    s_and_b32 s58, s3, 3
    s_lshl_b32 s58, s58, 7
    s_add_u32 s58, s58, 256
    v_lshlrev_b32 v75, 5, v3
    v_add_u32 v75, s58, v75
    s_mul_i32 s58, s6, 37888
    s_add_u32 s58, s58, s53
    s_and_b32 s60, s3, 3
    s_lshl_b32 s60, s60, 7
    s_add_u32 s58, s58, s60
    s_lshl_b32 s60, s7, 4
    s_add_u32 s58, s58, s60
    v_and_b32 v83, 1, v3
    v_lshrrev_b32 v84, 1, v1
    v_lshl_add_u32 v83, v83, 2, v84
    v_mul_u32_u24 v74, 4736, v83
    v_and_b32 v83, 1, v1
    v_lshl_add_u32 v74, v83, 3, v74
    v_lshrrev_b32 v83, 1, v3
    v_lshl_add_u32 v74, v83, 2, v74
    v_add_u32 v74, s58, v74
    s_mul_i32 s58, s7, 4736
    s_add_u32 s58, s58, s53
    v_add_u32 v68, s58, v76
    v_and_b32 v69, 15, v0
    v_lshlrev_b32 v69, 3, v69
    v_mov_b32 v72, 0
    s_and_b32 s58, s3, 3
    s_lshl_b32 s58, s58, 8
    v_add_u32 v80, s58, v76
    s_branch L_v_b2
L_k_rest:
    s_mov_b32 s14, 100663296
    s_mov_b32 s15, 0x20000
    s_mov_b32 s18, 100663296
    s_mov_b32 s19, 0x20000
    s_mov_b32 s26, 7864320
    s_mov_b32 s27, 0x20000
    s_mov_b32 s30, 1966080
    s_mov_b32 s31, 0x20000
    s_mov_b32 s34, 3072
    s_mov_b32 s35, 0x20000
    s_mov_b32 s38, 1966080
    s_mov_b32 s39, 0x20000
    s_mov_b32 s42, 1280
    s_mov_b32 s43, 0x20000
    s_mov_b32 s50, 1224704
    s_mov_b32 s51, 0x20000
    s_mul_i32 s53, s4, 151552
    s_mul_i32 s52, s5, 4736
    s_add_u32 s52, s52, s53
    s_cmp_ge_u32 s5, 10
    s_cselect_b32 s57, 1, 0
    s_cmp_ge_u32 s5, 20
    s_cselect_b32 s57, 2, s57
    s_cmp_ge_u32 s5, 30
    s_cselect_b32 s57, 3, s57
    s_mul_i32 s56, s57, 10
    s_sub_u32 s56, s5, s56
    v_lshlrev_b32 v71, 4, v1
    v_lshl_add_u32 v71, v3, 2, v71
    s_mov_b32 s54, 0
    s_mov_b32 s55, 0
    s_getreg_b32 s75, hwreg(HW_REG_XCC_ID)
    s_and_b32 s75, s75, 15
    s_mov_b32 s64, 0x00ff00ff
    s_mov_b32 s65, 0x00ff00ff
    s_mov_b32 s66, 0xaaaaaaaa
    s_mov_b32 s67, 0xaaaaaaaa
    s_mov_b32 s68, 0xcccccccc
    s_mov_b32 s69, 0xcccccccc
    s_mov_b32 s44, 0x03ff03ff
    s_mov_b32 s45, 0x03ff03ff
    s_mov_b32 s46, 1
    s_mov_b32 s47, 1
    s_buffer_load_dword s74, s[48:51], s71
    v_and_b32 v83, 1, v0
    v_mul_u32_u24 v83, 0x202, v83
    v_add_u32 v83, 0x100, v83
    v_bfe_u32 v84, v0, 1, 1
    v_lshlrev_b32 v84, 4, v84
    v_lshlrev_b32 v83, v84, v83
    v_mov_b32 v85, 0x0c0c0000
    v_lshrrev_b32 v85, v84, v85
    v_or_b32 v83, v83, v85
    v_bfe_u32 v84, v0, 2, 2
    v_mov_b32 v85, 0x0c0c0c0c
    v_cmp_eq_u32 vcc, 0, v84
    s_nop 1
    v_cndmask_b32 v8, v85, v83, vcc
    v_cmp_eq_u32 vcc, 1, v84
    s_nop 1
    v_cndmask_b32 v9, v85, v83, vcc
    v_cmp_eq_u32 vcc, 2, v84
    s_nop 1
    v_cndmask_b32 v10, v85, v83, vcc
    v_cmp_eq_u32 vcc, 3, v84
    s_nop 1
    v_cndmask_b32 v11, v85, v83, vcc
    v_mov_b32 v83, 0x3f803f80
    v_perm_b32 v4, v83, v83, v8
    v_perm_b32 v5, v83, v83, v9
    v_perm_b32 v6, v83, v83, v10
    v_perm_b32 v7, v83, v83, v11
    v_and_b32 v83, 1, v0
    v_lshlrev_b32 v83, 4, v83
    v_mov_b32 v84, 0xffff
    v_lshlrev_b32 v83, v83, v84
    v_and_b32 v84, 8, v0
    v_cmp_eq_u32 vcc, 0, v84
    v_mov_b32 v85, 0
    s_nop 0
    v_cndmask_b32 v56, v85, v83, vcc
    v_cndmask_b32 v57, v83, v85, vcc
    v_mov_b32 v83, 0x4444
    v_mov_b32 v84, 0xeeee
    v_cndmask_b32 v59, v84, v83, vcc
    v_bfe_u32 v83, v0, 1, 2
    v_mul_u32_u24 v58, 0x5555, v83
    v_lshrrev_b32 v83, 3, v0
    v_and_b32 v84, 7, v0
    s_mov_b32 s58, 151552
    v_mul_lo_u32 v72, s58, v83
    v_lshl_add_u32 v72, v84, 4, v72
    v_mul_u32_u24 v68, 4736, v84
    v_lshrrev_b32 v84, 4, v0
    v_lshl_add_u32 v68, v84, 6, v68
    s_lshl_b32 s58, s56, 2
    s_add_u32 s58, s58, s53
    v_add_u32 v68, s58, v68
    v_bfe_u32 v83, v0, 3, 1
    v_lshl_add_u32 v83, v83, 2, v84
    v_mul_u32_u24 v70, 4736, v83
    v_and_b32 v83, 7, v0
    v_lshl_add_u32 v70, v83, 4, v70
    s_mul_i32 s58, s6, 37888
    s_add_u32 s58, s58, s53
    v_add_u32 v70, s58, v70
    v_bfe_u32 v83, v0, 2, 2
    v_lshlrev_b32 v75, 5, v83
    v_lshl_add_u32 v75, v84, 3, v75
    v_and_b32 v83, 3, v0
    v_lshl_add_u32 v75, v83, 1, v75
    s_lshl_b32 s58, s3, 7
    s_add_u32 s58, s58, 256
    v_add_u32 v75, s58, v75
    v_and_b32 v83, 15, v0
    v_mul_u32_u24 v73, 4736, v84
    v_lshl_add_u32 v73, v83, 4, v73
    v_lshlrev_b32 v74, 4, v83
    v_lshl_add_u32 v74, v84, 2, v74
    v_lshlrev_b32 v69, 3, v83
    v_and_b32 v79, 7, v0
    v_lshlrev_b32 v79, 3, v79
    v_lshl_add_u32 v79, v84, 6, v79
    v_lshrrev_b32 v80, 3, v0
    v_and_b32 v80, 4, v80
    s_waitcnt lgkmcnt(0)
    s_mul_i32 s74, s74, 1664525
    s_add_u32 s74, s74, 1013904223
    s_waitcnt vmcnt(11)
    v_mov_b32 v83, 0
    v_mov_b32 v84, 0
    v_lshlrev_b32 v85, 16, v36
    v_and_b32 v86, 0xffff0000, v36
    v_add_f32 v83, v83, v85
    v_fmac_f32 v84, v85, v85
    v_add_f32 v83, v83, v86
    v_fmac_f32 v84, v86, v86
    v_lshlrev_b32 v85, 16, v37
    v_and_b32 v86, 0xffff0000, v37
    v_add_f32 v83, v83, v85
    v_fmac_f32 v84, v85, v85
    v_add_f32 v83, v83, v86
    v_fmac_f32 v84, v86, v86
    v_lshlrev_b32 v85, 16, v38
    v_and_b32 v86, 0xffff0000, v38
    v_add_f32 v83, v83, v85
    v_fmac_f32 v84, v85, v85
    v_add_f32 v83, v83, v86
    v_fmac_f32 v84, v86, v86
    v_lshlrev_b32 v85, 16, v39
    v_and_b32 v86, 0xffff0000, v39
    v_add_f32 v83, v83, v85
    v_fmac_f32 v84, v85, v85
    v_add_f32 v83, v83, v86
    v_fmac_f32 v84, v86, v86
    v_lshlrev_b32 v85, 16, v40
    v_and_b32 v86, 0xffff0000, v40
    v_add_f32 v83, v83, v85
    v_fmac_f32 v84, v85, v85
    v_add_f32 v83, v83, v86
    v_fmac_f32 v84, v86, v86
    v_mov_b32 v85, v83
    s_nop 1
    v_permlane16_swap_b32 v83, v85
    v_add_f32 v83, v83, v85
    v_mov_b32 v85, v83
    s_nop 1
    v_permlane32_swap_b32 v83, v85
    v_add_f32 v38, v83, v85
    v_mov_b32 v85, v84
    s_nop 1
    v_permlane16_swap_b32 v84, v85
    v_add_f32 v84, v84, v85
    v_mov_b32 v85, v84
    s_nop 1
    v_permlane32_swap_b32 v84, v85
    v_add_f32 v39, v84, v85
    s_waitcnt vmcnt(0)
    v_mfma_f32_16x16x32_bf16 v[24:27], v[4:7], v[184:187], 0
    v_mfma_f32_16x16x32_bf16 v[24:27], v[4:7], v[188:191], v[24:27]
    v_mfma_f32_16x16x32_bf16 v[24:27], v[4:7], v[192:195], v[24:27]
    v_mfma_f32_16x16x32_bf16 v[24:27], v[4:7], v[196:199], v[24:27]
    v_mfma_f32_16x16x32_bf16 v[24:27], v[4:7], v[200:203], v[24:27]
    v_mfma_f32_16x16x32_bf16 v[24:27], v[4:7], v[204:207], v[24:27]
    v_mfma_f32_16x16x32_bf16 v[24:27], v[4:7], v[208:211], v[24:27]
    v_mfma_f32_16x16x32_bf16 v[24:27], v[4:7], v[212:215], v[24:27]
    v_mfma_f32_16x16x32_bf16 v[24:27], v[4:7], v[216:219], v[24:27]
    v_mfma_f32_16x16x32_bf16 v[24:27], v[4:7], v[220:223], v[24:27]
    v_mov_b32 v20, 0
    v_mov_b32 v21, 0
    v_mov_b32 v22, 0
    v_mov_b32 v23, 0
    v_mov_b32 v36, v60
    s_nop 2
    v_add_f32_dpp v77, v25, v24 row_ror:8 row_mask:0xf bank_mask:0xf
    v_add_f32_dpp v78, v27, v26 row_ror:8 row_mask:0xf bank_mask:0xf
    s_branch L_qproj
L_qp_ret0:
    v_mov_b32 v66, v87
    v_mov_b32 v67, s74
    s_lshl_b32 s60, s3, 8
    s_add_u32 s63, s52, s60
    s_mov_b64 exec, s[64:65]
    buffer_store_dwordx2 v[66:67], v79, s[48:51], s63 offen offset:3840
    s_mov_b64 exec, -1
    s_mov_b32 s71, 0
    s_mul_i32 s58, s3, 10752
    s_add_u32 s58, s58, 106496
    v_lshlrev_b32 v83, 4, v0
    v_add_u32 v83, s58, v83
    ds_write_b128 v83, v[184:187] offset:0
    ds_write_b128 v83, v[188:191] offset:1024
    ds_write_b128 v83, v[192:195] offset:2048
    ds_write_b128 v83, v[196:199] offset:3072
    ds_write_b128 v83, v[200:203] offset:4096
    ds_write_b128 v83, v[204:207] offset:5120
    ds_write_b128 v83, v[208:211] offset:6144
    ds_write_b128 v83, v[212:215] offset:7168
    ds_write_b128 v83, v[216:219] offset:8192
    ds_write_b128 v83, v[220:223] offset:9216
    v_add_u32 v84, s58, v76
    ds_write_b32 v84, v77 offset:10240
    ds_write_b32 v84, v78 offset:10496
    s_mul_i32 s62, s6, 37888
    s_add_u32 s62, s62, s53
    s_lshl_b32 s58, s3, 7
    v_add_u32 v83, s58, v0
    v_mul_u32_u24 v84, 0x556, v83
    v_lshrrev_b32 v84, 16, v84
    v_mul_u32_u24 v85, 3968, v84
    v_lshl_add_u32 v61, v83, 4, v85
    v_add_u32 v83, s58, v0
    v_add_u32 v83, 64, v83
    v_mul_u32_u24 v84, 0x556, v83
    v_lshrrev_b32 v84, 16, v84
    v_mul_u32_u24 v85, 3968, v84
    v_lshl_add_u32 v62, v83, 4, v85
    s_mov_b32 s70, 0
    s_sleep 56
    s_add_u32 s58, s62, 768
    buffer_load_dwordx4 v[224:227], v61, s[48:51], s58 offen offset:3072 sc1
    buffer_load_dwordx4 v[228:231], v62, s[48:51], s58 offen offset:3072 sc1
    s_waitcnt vmcnt(0)
    v_mov_b32 v83, s74
    v_mov_b32 v84, s74
    v_min3_u32 v83, v83, v225, v227
    v_max3_u32 v84, v84, v225, v227
    v_min3_u32 v83, v83, v229, v231
    v_max3_u32 v84, v84, v229, v231
    v_cmp_ne_u32 vcc, v83, v84
    s_cbranch_vccz L_qg_3
    s_add_u32 s58, s62, 768
    buffer_load_dwordx4 v[224:227], v61, s[48:51], s58 offen offset:3072 sc1
    buffer_load_dwordx4 v[228:231], v62, s[48:51], s58 offen offset:3072 sc1
    s_sleep 24
    s_cmp_ge_u32 s70, 5
    s_cselect_b32 s58, 0, 768
    s_add_u32 s58, s58, s62
    buffer_load_dwordx4 v[232:235], v61, s[48:51], s58 offen offset:3072 sc1
    buffer_load_dwordx4 v[236:239], v62, s[48:51], s58 offen offset:3072 sc1
L_poll_1:
    s_waitcnt vmcnt(2)
    v_mov_b32 v83, s74
    v_mov_b32 v84, s74
    v_min3_u32 v83, v83, v225, v227
    v_max3_u32 v84, v84, v225, v227
    v_min3_u32 v83, v83, v229, v231
    v_max3_u32 v84, v84, v229, v231
    v_cmp_ne_u32 vcc, v83, v84
    s_cbranch_vccz L_qg_3
    s_add_u32 s58, s62, 768
    buffer_load_dwordx4 v[224:227], v61, s[48:51], s58 offen offset:3072 sc1
    buffer_load_dwordx4 v[228:231], v62, s[48:51], s58 offen offset:3072 sc1
    s_waitcnt vmcnt(2)
    v_mov_b32 v83, s74
    v_mov_b32 v84, s74
    v_min3_u32 v83, v83, v233, v235
    v_max3_u32 v84, v84, v233, v235
    v_min3_u32 v83, v83, v237, v239
    v_max3_u32 v84, v84, v237, v239
    v_cmp_ne_u32 vcc, v83, v84
    s_cbranch_vccz L_qg_4
    s_add_u32 s70, s70, 1
    s_cmp_lt_u32 s70, 5
    s_cbranch_scc1 L_qfb_5
    s_cmp_lg_u32 s71, 0
    s_cbranch_scc1 L_qfb_5
    s_cmp_eq_u32 s3, 3
    s_cbranch_scc1 L_qfb_5
    s_mov_b32 s71, 1
    s_mov_b64 exec, s[64:65]
    buffer_store_dwordx2 v[66:67], v79, s[48:51], s63 offen offset:3072 sc1
    s_mov_b64 exec, -1
    s_waitcnt vmcnt(0)
L_qfb_5:
    s_cmp_ge_u32 s70, 5
    s_cselect_b32 s58, 0, 768
    s_add_u32 s58, s58, s62
    buffer_load_dwordx4 v[232:235], v61, s[48:51], s58 offen offset:3072 sc1
    buffer_load_dwordx4 v[236:239], v62, s[48:51], s58 offen offset:3072 sc1
    s_cmp_lt_u32 s70, 200000
    s_cbranch_scc1 L_poll_1
L_qg_3:
    v_lshrrev_b32 v83, 4, v0
    v_lshlrev_b32 v83, 7, v83
    v_and_b32 v84, 3, v0
    v_lshl_add_u32 v83, v84, 4, v83
    v_bfe_u32 v84, v0, 2, 1
    v_lshl_add_u32 v83, v84, 6, v83
    v_bfe_u32 v84, v0, 3, 1
    v_lshl_add_u32 v83, v84, 2, v83
    s_lshl_b32 s58, s3, 10
    s_add_u32 s58, s58, 5120
    v_add_u32 v83, s58, v83
    ds_write2_b32 v83, v224, v226 offset0:0 offset1:2
    ds_write2_b32 v83, v228, v230 offset0:128 offset1:130
    s_branch L_got_2
L_qg_4:
    v_lshrrev_b32 v83, 4, v0
    v_lshlrev_b32 v83, 7, v83
    v_and_b32 v84, 3, v0
    v_lshl_add_u32 v83, v84, 4, v83
    v_bfe_u32 v84, v0, 2, 1
    v_lshl_add_u32 v83, v84, 6, v83
    v_bfe_u32 v84, v0, 3, 1
    v_lshl_add_u32 v83, v84, 2, v83
    s_lshl_b32 s58, s3, 10
    s_add_u32 s58, s58, 5120
    v_add_u32 v83, s58, v83
    ds_write2_b32 v83, v232, v234 offset0:0 offset1:2
    ds_write2_b32 v83, v236, v238 offset0:128 offset1:130
L_got_2:
    v_mov_b32 v85, 1
    v_mov_b32 v86, 32
    s_waitcnt lgkmcnt(0)
    ds_add_u32 v86, v85
    s_branch L_bk
L_c_rest:
    s_mov_b32 s14, 100663296
    s_mov_b32 s15, 0x20000
    s_mov_b32 s18, 100663296
    s_mov_b32 s19, 0x20000
    s_mov_b32 s22, 7864320
    s_mov_b32 s23, 0x20000
    s_mov_b32 s26, 7864320
    s_mov_b32 s27, 0x20000
    s_mov_b32 s30, 1966080
    s_mov_b32 s31, 0x20000
    s_mov_b32 s34, 3072
    s_mov_b32 s35, 0x20000
    s_mov_b32 s38, 1966080
    s_mov_b32 s39, 0x20000
    s_mov_b32 s42, 1280
    s_mov_b32 s43, 0x20000
    s_mov_b32 s54, 0
    s_mov_b32 s55, 0
    s_getreg_b32 s75, hwreg(HW_REG_XCC_ID)
    s_and_b32 s75, s75, 15
    s_mov_b32 s64, 0x00ff00ff
    s_mov_b32 s65, 0x00ff00ff
    s_mov_b32 s66, 0xaaaaaaaa
    s_mov_b32 s67, 0xaaaaaaaa
    s_mov_b32 s68, 0xcccccccc
    s_mov_b32 s69, 0xcccccccc
    s_mov_b32 s44, 0x03ff03ff
    s_mov_b32 s45, 0x03ff03ff
    s_mov_b32 s46, 1
    s_mov_b32 s47, 1
    s_buffer_load_dword s74, s[48:51], s71
    v_and_b32 v83, 1, v0
    v_mul_u32_u24 v83, 0x202, v83
    v_add_u32 v83, 0x100, v83
    v_bfe_u32 v84, v0, 1, 1
    v_lshlrev_b32 v84, 4, v84
    v_lshlrev_b32 v83, v84, v83
    v_mov_b32 v85, 0x0c0c0000
    v_lshrrev_b32 v85, v84, v85
    v_or_b32 v83, v83, v85
    v_bfe_u32 v84, v0, 2, 2
    v_mov_b32 v85, 0x0c0c0c0c
    v_cmp_eq_u32 vcc, 0, v84
    s_nop 1
    v_cndmask_b32 v8, v85, v83, vcc
    v_cmp_eq_u32 vcc, 1, v84
    s_nop 1
    v_cndmask_b32 v9, v85, v83, vcc
    v_cmp_eq_u32 vcc, 2, v84
    s_nop 1
    v_cndmask_b32 v10, v85, v83, vcc
    v_cmp_eq_u32 vcc, 3, v84
    s_nop 1
    v_cndmask_b32 v11, v85, v83, vcc
    v_mov_b32 v83, 0x3f803f80
    v_perm_b32 v4, v83, v83, v8
    v_perm_b32 v5, v83, v83, v9
    v_perm_b32 v6, v83, v83, v10
    v_perm_b32 v7, v83, v83, v11
    v_and_b32 v83, 1, v0
    v_lshlrev_b32 v83, 4, v83
    v_mov_b32 v84, 0xffff
    v_lshlrev_b32 v83, v83, v84
    v_and_b32 v84, 8, v0
    v_cmp_eq_u32 vcc, 0, v84
    v_mov_b32 v85, 0
    s_nop 0
    v_cndmask_b32 v56, v85, v83, vcc
    v_cndmask_b32 v57, v83, v85, vcc
    v_mov_b32 v83, 0x4444
    v_mov_b32 v84, 0xeeee
    v_cndmask_b32 v59, v84, v83, vcc
    v_bfe_u32 v83, v0, 1, 2
    v_mul_u32_u24 v58, 0x5555, v83
    v_lshrrev_b32 v83, 3, v0
    v_and_b32 v84, 7, v0
    s_mov_b32 s58, 151552
    v_mul_lo_u32 v72, s58, v83
    v_lshl_add_u32 v72, v84, 4, v72
    v_mul_u32_u24 v68, 4736, v84
    v_lshrrev_b32 v84, 4, v0
    v_lshl_add_u32 v68, v84, 6, v68
    s_lshl_b32 s58, s56, 2
    s_add_u32 s58, s58, s53
    v_add_u32 v68, s58, v68
    v_bfe_u32 v83, v0, 3, 1
    v_lshl_add_u32 v83, v83, 2, v84
    v_mul_u32_u24 v70, 4736, v83
    v_and_b32 v83, 7, v0
    v_lshl_add_u32 v70, v83, 4, v70
    s_mul_i32 s58, s6, 37888
    s_add_u32 s58, s58, s53
    v_add_u32 v70, s58, v70
    v_bfe_u32 v83, v0, 2, 2
    v_lshlrev_b32 v75, 5, v83
    v_lshl_add_u32 v75, v84, 3, v75
    v_and_b32 v83, 3, v0
    v_lshl_add_u32 v75, v83, 1, v75
    s_lshl_b32 s58, s3, 7
    s_add_u32 s58, s58, 256
    v_add_u32 v75, s58, v75
    v_and_b32 v83, 15, v0
    v_mul_u32_u24 v73, 4736, v84
    v_lshl_add_u32 v73, v83, 4, v73
    v_lshlrev_b32 v74, 4, v83
    v_lshl_add_u32 v74, v84, 2, v74
    v_lshlrev_b32 v69, 3, v83
    v_and_b32 v79, 7, v0
    v_lshlrev_b32 v79, 3, v79
    v_lshl_add_u32 v79, v84, 6, v79
    v_lshrrev_b32 v80, 3, v0
    v_and_b32 v80, 4, v80
    s_waitcnt lgkmcnt(0)
    s_mul_i32 s74, s74, 1664525
    s_add_u32 s74, s74, 1013904223
    s_waitcnt vmcnt(0)
    s_xor_b32 s58, s74, 0x5bd1e995
    s_andn2_b32 s58, s58, 15
    s_or_b32 s75, s75, s58
    s_lshl_b32 s58, s4, 5
    s_add_u32 s58, s58, s5
    s_lshl_b32 s58, s58, 3
    s_add_u32 s58, s58, 1216512
    v_mov_b32 v64, s74
    v_mov_b32 v65, s75
    s_mov_b64 exec, 1
    buffer_store_dwordx2 v[64:65], v71, s[48:51], s58 offen sc1
    s_mov_b64 exec, -1
    s_sleep 127
    v_lshlrev_b32 v87, 5, v0
    s_mov_b32 s60, 1216512
    buffer_load_dwordx4 v[12:15], v87, s[48:51], s60 offen sc1
    buffer_load_dwordx4 v[16:19], v87, s[48:51], s60 offen offset:16 sc1
    s_lshl_b32 s58, s4, 3
    s_mov_b64 s[72:73], 0xff
    s_lshl_b64 s[72:73], s[72:73], s58
    s_mov_b32 s70, 0
    s_or_b32 s61, s75, 15
    s_branch L_fc_8
L_fp_7:
    v_lshlrev_b32 v87, 5, v0
    s_mov_b32 s60, 1216512
    buffer_load_dwordx4 v[12:15], v87, s[48:51], s60 offen sc1
    buffer_load_dwordx4 v[16:19], v87, s[48:51], s60 offen offset:16 sc1
L_fc_8:
    s_waitcnt vmcnt(0)
    v_xor_b32 v85, s74, v12
    v_xor_b32 v86, s74, v14
    v_or_b32 v85, v85, v86
    v_xor_b32 v86, s74, v16
    v_or_b32 v85, v85, v86
    v_xor_b32 v86, s74, v18
    v_or_b32 v85, v85, v86
    v_or_b32 v86, 15, v13
    v_xor_b32 v86, s61, v86
    v_or_b32 v85, v85, v86
    v_or_b32 v86, 15, v15
    v_xor_b32 v86, s61, v86
    v_or_b32 v85, v85, v86
    v_or_b32 v86, 15, v17
    v_xor_b32 v86, s61, v86
    v_or_b32 v85, v85, v86
    v_or_b32 v86, 15, v19
    v_xor_b32 v86, s61, v86
    v_or_b32 v85, v85, v86
    v_cmp_ne_u32 vcc, 0, v85
    s_cbranch_vccz L_fg_9
    s_sleep 16
    s_add_u32 s70, s70, 1
    s_cmp_lt_u32 s70, 200000
    s_cbranch_scc1 L_fp_7
L_fg_9:
    v_xor_b32 v85, s75, v13
    v_xor_b32 v86, s75, v15
    v_or_b32 v85, v85, v86
    v_xor_b32 v86, s75, v17
    v_or_b32 v85, v85, v86
    v_xor_b32 v86, s75, v19
    v_or_b32 v85, v85, v86
    v_cmp_ne_u32 vcc, 0, v85
    s_mov_b32 s55, 1
    s_and_b64 vcc, vcc, s[72:73]
    s_cbranch_scc0 L_fast_6
    s_mov_b32 s55, 0
    v_mov_b32 v64, -1
    v_mov_b32 v65, -1
    v_mov_b32 v66, -1
    v_mov_b32 v67, -1
    v_lshlrev_b32 v86, 4, v0
    s_mov_b32 exec_hi, 0
    buffer_store_dwordx4 v[64:67], v86, s[48:51], s52 offen sc1
    s_mov_b32 exec_lo, 0xffff
    buffer_store_dwordx4 v[64:67], v86, s[48:51], s52 offen offset:2560 sc1
    s_mov_b64 exec, -1
    buffer_store_dwordx4 v[64:67], v86, s[48:51], s52 offen offset:512 sc1
    buffer_store_dwordx4 v[64:67], v86, s[48:51], s52 offen offset:1536 sc1
    s_waitcnt vmcnt(0)
    s_lshl_b32 s58, s4, 5
    s_add_u32 s58, s58, s5
    s_lshl_b32 s58, s58, 3
    s_add_u32 s58, s58, 1220608
    v_mov_b32 v64, s74
    v_mov_b32 v65, s75
    s_mov_b64 exec, 1
    buffer_store_dwordx2 v[64:65], v71, s[48:51], s58 offen sc1
    s_mov_b64 exec, -1
    s_mov_b32 s70, 0
    s_or_b32 s61, s75, 15
L_fp_10:
    v_lshlrev_b32 v87, 5, v0
    s_mov_b32 s60, 1220608
    buffer_load_dwordx4 v[12:15], v87, s[48:51], s60 offen sc1
    buffer_load_dwordx4 v[16:19], v87, s[48:51], s60 offen offset:16 sc1
L_fc_11:
    s_waitcnt vmcnt(0)
    v_xor_b32 v85, s74, v12
    v_xor_b32 v86, s74, v14
    v_or_b32 v85, v85, v86
    v_xor_b32 v86, s74, v16
    v_or_b32 v85, v85, v86
    v_xor_b32 v86, s74, v18
    v_or_b32 v85, v85, v86
    v_or_b32 v86, 15, v13
    v_xor_b32 v86, s61, v86
    v_or_b32 v85, v85, v86
    v_or_b32 v86, 15, v15
    v_xor_b32 v86, s61, v86
    v_or_b32 v85, v85, v86
    v_or_b32 v86, 15, v17
    v_xor_b32 v86, s61, v86
    v_or_b32 v85, v85, v86
    v_or_b32 v86, 15, v19
    v_xor_b32 v86, s61, v86
    v_or_b32 v85, v85, v86
    v_cmp_ne_u32 vcc, 0, v85
    s_nop 0
    s_and_b64 vcc, vcc, s[72:73]
    s_cbranch_scc0 L_fg_12
    s_sleep 16
    s_add_u32 s70, s70, 1
    s_cmp_lt_u32 s70, 200000
    s_cbranch_scc1 L_fp_10
L_fg_12:
L_fast_6:
    s_lshl_b32 s58, s55, 1
    s_or_b32 s58, s58, 1
    v_mov_b32 v85, s58
    v_mov_b32 v86, 0
    ds_write_b32 v86, v85 offset:4
    s_waitcnt vmcnt(0)
    v_lshlrev_b32 v64, 16, v40
    v_and_b32 v66, 0xffff0000, v40
    v_mov_b32 v65, 0
    v_mov_b32 v67, 0
L_bk:
    s_lshl_b32 s60, s3, 2
    s_add_u32 s60, s60, 16
    v_mov_b32 v2, s60
    s_mov_b32 s70, 0
L_lw_13:
    ds_read_b32 v1, v2
    s_waitcnt lgkmcnt(0)
    v_readfirstlane_b32 s58, v1
    s_nop 0
    s_cmp_lg_u32 s58, 0
    s_cbranch_scc1 L_lg_14
    s_sleep 1
    s_add_u32 s70, s70, 1
    s_cmp_lt_u32 s70, 800000
    s_cbranch_scc1 L_lw_13
L_lg_14:
    v_and_b32 v83, 7, v0
    v_lshrrev_b32 v84, 4, v0
    v_and_b32 v85, 6, v0
    v_xor_b32 v84, v84, v85
    v_lshlrev_b32 v83, 7, v83
    v_bfe_u32 v85, v0, 3, 1
    v_mul_u32_u24 v85, 3072, v85
    v_add_u32 v83, v83, v85
    s_mul_i32 s60, s3, 24576
    v_add_u32 v83, s60, v83
    v_lshl_add_u32 v85, v84, 4, v83
    v_xor_b32 v84, 4, v84
    v_lshl_add_u32 v84, v84, 4, v83
    ds_read_b128 v[88:91], v85 offset:8192
    ds_read_b128 v[92:95], v84 offset:8192
    ds_read_b128 v[96:99], v85 offset:9216
    ds_read_b128 v[100:103], v84 offset:9216
    ds_read_b128 v[104:107], v85 offset:10240
    ds_read_b128 v[108:111], v84 offset:10240
    ds_read_b128 v[112:115], v85 offset:14336
    ds_read_b128 v[116:119], v84 offset:14336
    ds_read_b128 v[120:123], v85 offset:15360
    ds_read_b128 v[124:127], v84 offset:15360
    ds_read_b128 v[128:131], v85 offset:16384
    ds_read_b128 v[132:135], v84 offset:16384
    s_waitcnt lgkmcnt(0)
    ds_read_b128 v[136:139], v85 offset:20480
    ds_read_b128 v[140:143], v84 offset:20480
    ds_read_b128 v[144:147], v85 offset:21504
    ds_read_b128 v[148:151], v84 offset:21504
    ds_read_b128 v[152:155], v85 offset:22528
    ds_read_b128 v[156:159], v84 offset:22528
    ds_read_b128 v[160:163], v85 offset:26624
    ds_read_b128 v[164:167], v84 offset:26624
    ds_read_b128 v[168:171], v85 offset:27648
    ds_read_b128 v[172:175], v84 offset:27648
    ds_read_b128 v[176:179], v85 offset:28672
    ds_read_b128 v[180:183], v84 offset:28672
    s_waitcnt lgkmcnt(0)
    v_mov_b32 v2, 32
    s_mov_b32 s70, 0
L_lw_15:
    ds_read_b32 v1, v2
    s_waitcnt lgkmcnt(0)
    v_readfirstlane_b32 s58, v1
    s_nop 0
    s_cmp_eq_u32 s58, 192
    s_cbranch_scc1 L_lg_16
    s_sleep 1
    s_add_u32 s70, s70, 1
    s_cmp_lt_u32 s70, 64
    s_cbranch_scc1 L_qfb_17
    s_cmp_lg_u32 s71, 0
    s_cbranch_scc1 L_qfb_17
    s_cmp_eq_u32 s3, 3
    s_cbranch_scc1 L_qfb_17
    s_mov_b32 s71, 1
    s_mov_b64 exec, s[64:65]
    buffer_store_dwordx2 v[66:67], v79, s[48:51], s63 offen offset:3072 sc1
    s_mov_b64 exec, -1
    s_waitcnt vmcnt(0)
L_qfb_17:
    s_cmp_lt_u32 s70, 800000
    s_cbranch_scc1 L_lw_15
L_lg_16:
    v_and_b32 v86, 7, v0
    v_mul_u32_u24 v86, 384, v86
    v_lshrrev_b32 v87, 4, v0
    v_lshl_add_u32 v86, v87, 4, v86
    v_and_b32 v87, 8, v0
    v_lshl_add_u32 v86, v87, 3, v86
    ds_read_b128 v[36:39], v86 offset:5120
    ds_read_b128 v[40:43], v86 offset:5248
    ds_read_b128 v[44:47], v86 offset:5376
    v_mov_b32 v20, 0
    v_mov_b32 v21, 0
    v_mov_b32 v22, 0
    v_mov_b32 v23, 0
    v_mov_b32 v24, 0
    v_mov_b32 v25, 0
    v_mov_b32 v26, 0
    v_mov_b32 v27, 0
    v_mov_b32 v28, 0
    v_mov_b32 v29, 0
    v_mov_b32 v30, 0
    v_mov_b32 v31, 0
    v_mov_b32 v32, 0
    v_mov_b32 v33, 0
    v_mov_b32 v34, 0
    v_mov_b32 v35, 0
    s_waitcnt lgkmcnt(0)
    s_branch L_qk
L_kloop:
    s_cmp_lg_u32 s3, 3
    s_cbranch_scc1 L_k_b1
    s_cmp_ge_u32 s5, 10
    s_cbranch_scc1 L_k_pt
    s_lshl_b32 s63, s56, 3
    s_add_u32 s63, s63, s53
    s_add_u32 s63, s63, 33152
    s_mul_i32 s58, s56, 4736
    s_add_u32 s60, s58, 47360
    s_add_u32 s61, s58, 94720
    s_sleep 11
    s_mov_b32 s70, 0
L_poll_18:
    buffer_load_dwordx4 v[36:39], v72, s[48:51], s58 offen offset:256 sc1
    buffer_load_dwordx4 v[40:43], v72, s[48:51], s60 offen offset:256 sc1
    buffer_load_dwordx4 v[44:47], v72, s[48:51], s61 offen offset:256 sc1
    s_add_u32 s70, s70, 1
    s_cmp_lt_u32 s70, 200000
    s_cbranch_scc0 L_retry_19
.p2align 3
    s_nop 0
    s_waitcnt vmcnt(0)
    v_mfma_f32_16x16x32_bf16 v[20:23], v[4:7], v[36:39], v[64:67]
    v_max3_u32 v3, v36, v37, v38
    v_max3_u32 v3, v3, v39, v40
    v_mfma_f32_16x16x32_bf16 v[20:23], v[4:7], v[40:43], v[20:23]
    v_max3_u32 v3, v3, v41, v42
    v_max3_u32 v3, v3, v43, v44
    v_mfma_f32_16x16x32_bf16 v[20:23], v[4:7], v[44:47], v[20:23]
    v_max3_u32 v3, v3, v45, v46
    v_max_u32 v3, v3, v47
    v_cmp_eq_u32 vcc, -1, v3
    s_cbranch_vccnz L_poll_18
L_got_20:
    s_nop 3
    v_add_f32_dpp v85, v21, v20 row_ror:8 row_mask:0xf bank_mask:0xf
    v_add_f32_dpp v86, v23, v22 row_ror:8 row_mask:0xf bank_mask:0xf
    v_cvt_pk_bf16_f32 v87, v85, v86
    s_mov_b64 exec, s[64:65]
    s_cmp_eq_u32 s55, 0
    s_cbranch_scc1 L_sl_21
    buffer_store_dword v87, v68, s[48:51], 0 offen offset:2560
L_sd_22:
    s_mov_b64 exec, -1
    v_lshlrev_b32 v64, 16, v87
    v_and_b32 v66, 0xffff0000, v87
    v_add_f32 v83, v64, v66
    v_mul_f32 v84, v64, v64
    v_fmac_f32 v84, v66, v66
    s_nop 1
    v_permlane32_swap_b32 v83, v84
    v_add_f32 v83, v83, v84
    v_mov_b32 v85, v83
    s_nop 1
    v_permlane16_swap_b32 v83, v85
    v_add_f32 v83, v83, v85
    s_nop 1
    v_add_f32_dpp v83, v83, v83 quad_perm:[1,0,3,2] row_mask:0xf bank_mask:0xf
    s_nop 1
    v_add_f32_dpp v83, v83, v83 quad_perm:[2,3,0,1] row_mask:0xf bank_mask:0xf
    s_nop 1
    v_add_f32_dpp v83, v83, v83 row_half_mirror row_mask:0xf bank_mask:0xf
    s_mov_b64 exec, s[46:47]
    s_cmp_eq_u32 s55, 0
    s_cbranch_scc1 L_sl_23
    buffer_store_dword v83, v80, s[48:51], s63 offen offset:1664
L_sd_24:
    s_mov_b64 exec, -1
L_k_pt:
L_k_b1:
    v_mov_b32 v20, 0
    v_mov_b32 v21, 0
    v_mov_b32 v22, 0
    v_mov_b32 v23, 0
    v_mov_b32 v24, 0
    v_mov_b32 v25, 0
    v_mov_b32 v26, 0
    v_mov_b32 v27, 0
    v_mov_b32 v28, 0
    v_mov_b32 v29, 0
    v_mov_b32 v30, 0
    v_mov_b32 v31, 0
    v_mov_b32 v32, 0
    v_mov_b32 v33, 0
    v_mov_b32 v34, 0
    v_mov_b32 v35, 0
    s_barrier
    s_sleep 10
    s_mov_b32 s70, 0
L_poll_25:
    buffer_load_dwordx4 v[36:39], v70, s[48:51], 0 offen offset:512 sc1
    buffer_load_dwordx4 v[40:43], v70, s[48:51], 0 offen offset:640 sc1
    buffer_load_dwordx4 v[44:47], v70, s[48:51], 0 offen offset:768 sc1
    s_add_u32 s70, s70, 1
    s_cmp_lt_u32 s70, 200000
    s_cbranch_scc0 L_retry_26
L_qk:
.p2align 3
    s_nop 0
    s_waitcnt vmcnt(0)
    v_max3_u32 v3, v36, v37, v38
    v_max3_u32 v3, v3, v39, v40
    v_max3_u32 v3, v3, v41, v42
    v_max3_u32 v3, v3, v43, v44
    v_max3_u32 v3, v3, v45, v46
    v_max_u32 v3, v3, v47
    v_cmp_eq_u32 vcc, -1, v3
    s_cbranch_vccnz L_poll_25
L_got_27:
    v_smfmac_f32_16x16x64_bf16 v[20:23], v[36:39], v[88:95], v59
    v_smfmac_f32_16x16x64_bf16 v[20:23], v[40:43], v[96:103], v59
    v_smfmac_f32_16x16x64_bf16 v[20:23], v[44:47], v[104:111], v59
    v_smfmac_f32_16x16x64_bf16 v[28:31], v[36:39], v[136:143], v59
    v_smfmac_f32_16x16x64_bf16 v[28:31], v[40:43], v[144:151], v59
    v_smfmac_f32_16x16x64_bf16 v[28:31], v[44:47], v[152:159], v59
    v_smfmac_f32_16x16x64_bf16 v[24:27], v[36:39], v[112:119], v59
    v_smfmac_f32_16x16x64_bf16 v[24:27], v[40:43], v[120:127], v59
    v_smfmac_f32_16x16x64_bf16 v[24:27], v[44:47], v[128:135], v59
    s_nop 1
    v_add_f32 v60, v20, v21
    v_add_f32 v85, v22, v23
    v_add_f32 v60, v60, v85
    v_smfmac_f32_16x16x64_bf16 v[32:35], v[36:39], v[160:167], v59
    v_smfmac_f32_16x16x64_bf16 v[32:35], v[40:43], v[168:175], v59
    v_smfmac_f32_16x16x64_bf16 v[32:35], v[44:47], v[176:183], v59
    v_add_f32 v62, v28, v29
    v_add_f32 v85, v30, v31
    v_add_f32 v62, v62, v85
    s_nop 1
    v_permlane32_swap_b32 v60, v62
    v_add_f32 v61, v24, v25
    v_add_f32 v85, v26, v27
    v_add_f32 v61, v61, v85
    v_add_f32 v60, v60, v62
    v_add_f32 v63, v32, v33
    v_add_f32 v85, v34, v35
    v_add_f32 v63, v63, v85
    s_nop 1
    v_permlane32_swap_b32 v61, v63
    v_add_f32 v61, v61, v63
    s_nop 1
    v_permlane16_swap_b32 v60, v61
    v_add_f32 v83, v60, v61
    v_mul_f32 v83, 0x3dd53b95, v83
    s_nop 1
    v_max_f32_dpp v84, v83, v83 quad_perm:[1,0,3,2] row_mask:0xf bank_mask:0xf
    s_nop 1
    v_max_f32_dpp v84, v84, v84 quad_perm:[2,3,0,1] row_mask:0xf bank_mask:0xf
    s_nop 1
    v_max_f32_dpp v84, v84, v84 row_half_mirror row_mask:0xf bank_mask:0xf
    s_nop 1
    v_max_f32_dpp v84, v84, v84 row_mirror row_mask:0xf bank_mask:0xf
    v_mov_b32 v85, v84
    s_nop 1
    v_permlane16_swap_b32 v84, v85
    v_max_f32 v84, v84, v85
    v_mov_b32 v85, v84
    s_nop 1
    v_permlane32_swap_b32 v84, v85
    v_max_f32 v84, v84, v85
    v_sub_f32 v83, v83, v84
    v_exp_f32 v83, v83
    s_nop 0
    v_cvt_pk_bf16_f32 v83, v83, v83
    ds_write_b16 v75, v83
    s_cmp_eq_u32 s3, 3
    s_cbranch_scc1 L_qk_nf
    s_cmp_lg_u32 s54, 0
    s_cbranch_scc1 L_qk_nf
    v_mov_b32 v2, 4
    s_mov_b32 s70, 0
L_lw_28:
    ds_read_b32 v1, v2
    s_waitcnt lgkmcnt(0)
    v_readfirstlane_b32 s58, v1
    s_nop 0
    s_cmp_lg_u32 s58, 0
    s_cbranch_scc1 L_lg_29
    s_sleep 1
    s_add_u32 s70, s70, 1
    s_cmp_lt_u32 s70, 800000
    s_cbranch_scc1 L_lw_28
L_lg_29:
    s_lshr_b32 s55, s58, 1
    s_cmp_lg_u32 s55, 0
    s_cbranch_scc1 L_qk_nf
    s_cmp_lt_u32 s70, 0
    s_cbranch_scc1 L_qfb_30
    s_cmp_lg_u32 s71, 0
    s_cbranch_scc1 L_qfb_30
    s_cmp_eq_u32 s3, 3
    s_cbranch_scc1 L_qfb_30
    s_mov_b32 s71, 1
    s_mov_b64 exec, s[64:65]
    buffer_store_dwordx2 v[66:67], v79, s[48:51], s63 offen offset:3072 sc1
    s_mov_b64 exec, -1
    s_waitcnt vmcnt(0)
L_qfb_30:
L_qk_nf:
    s_waitcnt lgkmcnt(0)
    s_barrier
    v_lshlrev_b32 v83, 16, v83
    s_nop 1
    v_add_f32_dpp v83, v83, v83 quad_perm:[1,0,3,2] row_mask:0xf bank_mask:0xf
    s_nop 1
    v_add_f32_dpp v83, v83, v83 quad_perm:[2,3,0,1] row_mask:0xf bank_mask:0xf
    s_nop 1
    v_add_f32_dpp v83, v83, v83 row_half_mirror row_mask:0xf bank_mask:0xf
    s_nop 1
    v_add_f32_dpp v83, v83, v83 row_mirror row_mask:0xf bank_mask:0xf
    v_mov_b32 v85, v83
    s_nop 1
    v_permlane16_swap_b32 v83, v85
    v_add_f32 v83, v83, v85
    v_mov_b32 v85, v83
    s_nop 1
    v_permlane32_swap_b32 v83, v85
    v_add_f32 v83, v83, v85
    s_lshl_b32 s58, s3, 3
    v_mov_b32 v85, s58
    s_mov_b64 exec, 1
    ds_write_b32 v85, v84 offset:128
    ds_write_b32 v85, v83 offset:132
    s_mov_b64 exec, -1
    s_cmp_lg_u32 s3, 3
    s_cbranch_scc1 L_k_b3
    s_waitcnt lgkmcnt(0)
    s_barrier
    s_cmp_ge_u32 s5, 30
    s_cbranch_scc1 L_k_next
    s_cmp_eq_u32 s54, 0
    s_cbranch_scc1 L_c_nx2
    s_cmp_lt_u32 s5, 10
    s_cbranch_scc1 L_c_nx2
    s_mov_b32 s70, 0
L_poll_31:
    buffer_load_dword v36, v68, s[48:51], 0 offen offset:2560 sc1
    s_add_u32 s70, s70, 1
    s_cmp_lt_u32 s70, 200000
    s_cbranch_scc0 L_retry_32
.p2align 3
    s_nop 0
    s_waitcnt vmcnt(0)
    v_cmp_eq_u32 vcc, -1, v36
    s_cbranch_vccnz L_poll_31
L_got_33:
    v_lshlrev_b32 v64, 16, v36
    v_and_b32 v66, 0xffff0000, v36
L_c_nx2:
    s_cmp_lg_u32 s54, 0
    s_cbranch_scc1 L_c_nb3b
    s_barrier
    v_bfe_u32 v85, v0, 3, 1
    v_lshrrev_b32 v86, 5, v0
    v_lshl_add_u32 v85, v86, 1, v85
    v_bfe_u32 v86, v0, 4, 1
    v_lshl_add_u32 v85, v86, 3, v85
    v_and_b32 v86, 7, v0
    v_mul_u32_u24 v85, 3072, v85
    v_lshl_add_u32 v85, v86, 4, v85
    s_mul_i32 s58, s56, 196608
    s_mul_i32 s60, s4, 384
    s_add_u32 s58, s58, s60
    s_lshl_b32 s60, s57, 7
    s_add_u32 s58, s58, s60
    buffer_load_dwordx4 v[224:227], v85, s[28:31], s58 offen nt
    s_add_u32 s58, s58, 12288
    buffer_load_dwordx4 v[228:231], v85, s[28:31], s58 offen nt
    s_add_u32 s58, s58, 36864
    buffer_load_dwordx4 v[232:235], v85, s[28:31], s58 offen nt
    s_add_u32 s58, s58, 12288
    buffer_load_dwordx4 v[236:239], v85, s[28:31], s58 offen nt
    s_add_u32 s58, s58, 36864
    buffer_load_dwordx4 v[240:243], v85, s[28:31], s58 offen nt
    s_add_u32 s58, s58, 12288
    buffer_load_dwordx4 v[244:247], v85, s[28:31], s58 offen nt
    s_add_u32 s58, s58, 36864
    buffer_load_dwordx4 v[248:251], v85, s[28:31], s58 offen nt
    s_add_u32 s58, s58, 12288
    buffer_load_dwordx4 v[252:255], v85, s[28:31], s58 offen nt
L_c_nb3b:
    s_barrier
    v_mov_b32 v24, 0
    v_mov_b32 v25, 0
    v_mov_b32 v26, 0
    v_mov_b32 v27, 0
    s_mul_i32 s62, s54, 256
    s_add_u32 s62, s62, 1792
    s_add_u32 s62, s62, s52
    s_mul_i32 s63, s54, 3
    s_add_u32 s63, s63, s57
    s_add_u32 s63, s63, 1
    s_mul_i32 s63, s63, 4736
    s_add_u32 s63, s63, s53
    s_lshl_b32 s61, s56, 3
    s_add_u32 s63, s63, s61
    s_cmp_lg_u32 s54, 0
    s_cbranch_scc1 L_p4_nocs
    s_mul_i32 s58, s54, 128
    s_mul_i32 s60, s56, 4736
    s_add_u32 s58, s58, s60
    s_add_u32 s60, s58, 47360
    s_add_u32 s61, s58, 94720
    s_sleep 16
    buffer_load_dwordx4 v[36:39], v72, s[48:51], s58 offen sc1
    buffer_load_dwordx4 v[40:43], v72, s[48:51], s60 offen sc1
    buffer_load_dwordx4 v[44:47], v72, s[48:51], s61 offen sc1
    s_mov_b32 s70, 0
    s_waitcnt vmcnt(3)
    v_mfma_f32_16x16x32_bf16 v[20:23], v[4:7], v[224:227], 0
    v_mfma_f32_16x16x32_bf16 v[20:23], v[4:7], v[228:231], v[20:23]
    v_mfma_f32_16x16x32_bf16 v[20:23], v[4:7], v[232:235], v[20:23]
    v_mfma_f32_16x16x32_bf16 v[20:23], v[4:7], v[236:239], v[20:23]
    v_mfma_f32_16x16x32_bf16 v[20:23], v[4:7], v[240:243], v[20:23]
    v_mfma_f32_16x16x32_bf16 v[20:23], v[4:7], v[244:247], v[20:23]
    v_mfma_f32_16x16x32_bf16 v[20:23], v[4:7], v[248:251], v[20:23]
    v_mfma_f32_16x16x32_bf16 v[20:23], v[4:7], v[252:255], v[20:23]
    s_nop 7
    v_add_f32_dpp v77, v21, v20 row_ror:8 row_mask:0xf bank_mask:0x3
    v_add_f32_dpp v77, v22, v23 row_ror:8 row_mask:0xf bank_mask:0xc
    s_cmp_eq_u32 s55, 0
    s_cbranch_scc1 L_sl_34
    buffer_store_dword v77, v74, s[48:51], s52 offen offset:2304
L_sd_35:
    s_branch L_p4_chk
L_p4_nocs:
    s_mul_i32 s58, s54, 128
    s_mul_i32 s60, s56, 4736
    s_add_u32 s58, s58, s60
    s_add_u32 s60, s58, 47360
    s_add_u32 s61, s58, 94720
    s_sleep 14
    s_mov_b32 s70, 0
L_poll_36:
    buffer_load_dwordx4 v[36:39], v72, s[48:51], s58 offen sc1
    buffer_load_dwordx4 v[40:43], v72, s[48:51], s60 offen sc1
    buffer_load_dwordx4 v[44:47], v72, s[48:51], s61 offen sc1
    s_add_u32 s70, s70, 1
    s_cmp_lt_u32 s70, 200000
    s_cbranch_scc0 L_retry_37
L_p4_chk:
.p2align 3
    s_nop 0
    s_waitcnt vmcnt(0)
    v_mfma_f32_16x16x32_bf16 v[20:23], v[4:7], v[36:39], v[64:67]
    v_max3_u32 v3, v36, v37, v38
    v_max3_u32 v3, v3, v39, v40
    v_mfma_f32_16x16x32_bf16 v[20:23], v[4:7], v[40:43], v[20:23]
    v_max3_u32 v3, v3, v41, v42
    v_max3_u32 v3, v3, v43, v44
    v_mfma_f32_16x16x32_bf16 v[20:23], v[4:7], v[44:47], v[20:23]
    v_max3_u32 v3, v3, v45, v46
    v_max_u32 v3, v3, v47
    v_cmp_eq_u32 vcc, -1, v3
    s_cbranch_vccnz L_poll_36
L_got_38:
    s_barrier
    s_nop 2
    v_add_f32_dpp v85, v21, v20 row_ror:8 row_mask:0xf bank_mask:0xf
    v_add_f32_dpp v86, v23, v22 row_ror:8 row_mask:0xf bank_mask:0xf
    v_cvt_pk_bf16_f32 v87, v85, v86
.p2align 3
    s_nop 1
    v_and_b32_dpp v12, v87, v56 row_newbcast:0 row_mask:0xf bank_mask:0xf
    v_and_b32_dpp v13, v87, v57 row_newbcast:0 row_mask:0xf bank_mask:0xf
    v_lshlrev_b32 v64, 16, v87
    v_and_b32_dpp v14, v87, v56 row_newbcast:1 row_mask:0xf bank_mask:0xf
    v_and_b32_dpp v15, v87, v57 row_newbcast:1 row_mask:0xf bank_mask:0xf
    v_and_b32 v66, 0xffff0000, v87
    v_and_b32_dpp v16, v87, v56 row_newbcast:2 row_mask:0xf bank_mask:0xf
    v_and_b32_dpp v17, v87, v57 row_newbcast:2 row_mask:0xf bank_mask:0xf
    v_smfmac_f32_16x16x64_bf16 v[24:27], v[12:15], v[224:231], v58
    v_add_f32 v83, v64, v66
    v_and_b32_dpp v18, v87, v56 row_newbcast:3 row_mask:0xf bank_mask:0xf
    v_and_b32_dpp v19, v87, v57 row_newbcast:3 row_mask:0xf bank_mask:0xf
    v_mul_f32 v84, v64, v64
    v_and_b32_dpp v12, v87, v56 row_newbcast:4 row_mask:0xf bank_mask:0xf
    v_and_b32_dpp v13, v87, v57 row_newbcast:4 row_mask:0xf bank_mask:0xf
    v_smfmac_f32_16x16x64_bf16 v[24:27], v[16:19], v[232:239], v58
    v_fmac_f32 v84, v66, v66
    v_and_b32_dpp v14, v87, v56 row_newbcast:5 row_mask:0xf bank_mask:0xf
    v_and_b32_dpp v15, v87, v57 row_newbcast:5 row_mask:0xf bank_mask:0xf
    v_permlane32_swap_b32 v83, v84
    v_and_b32_dpp v16, v87, v56 row_newbcast:6 row_mask:0xf bank_mask:0xf
    v_and_b32_dpp v17, v87, v57 row_newbcast:6 row_mask:0xf bank_mask:0xf
    v_smfmac_f32_16x16x64_bf16 v[24:27], v[12:15], v[240:247], v58
    v_add_f32 v83, v83, v84
    v_and_b32_dpp v18, v87, v56 row_newbcast:7 row_mask:0xf bank_mask:0xf
    v_and_b32_dpp v19, v87, v57 row_newbcast:7 row_mask:0xf bank_mask:0xf
    v_mov_b32 v85, v83
    s_nop 1
    v_permlane16_swap_b32 v83, v85
    v_add_f32 v83, v83, v85
    v_smfmac_f32_16x16x64_bf16 v[24:27], v[16:19], v[248:255], v58
    s_nop 0
    v_add_f32_dpp v83, v83, v83 quad_perm:[1,0,3,2] row_mask:0xf bank_mask:0xf
    s_nop 1
    v_add_f32_dpp v83, v83, v83 quad_perm:[2,3,0,1] row_mask:0xf bank_mask:0xf
    s_nop 1
    v_add_f32_dpp v83, v83, v83 row_half_mirror row_mask:0xf bank_mask:0xf
    v_add_f32_dpp v86, v25, v24 row_ror:8 row_mask:0xf bank_mask:0x3
    v_add_f32_dpp v86, v26, v27 row_ror:8 row_mask:0xf bank_mask:0xc
    s_cmp_eq_u32 s55, 0
    s_cbranch_scc1 L_sl_39
    buffer_store_dword v86, v74, s[48:51], s62 offen
    s_mov_b64 exec, s[46:47]
    buffer_store_dword v83, v80, s[48:51], s63 offen offset:1664
L_sd_40:
    s_mov_b64 exec, -1
    s_barrier
    s_cmp_lg_u32 s54, 0
    s_cbranch_scc1 L_final
    s_mov_b32 s54, 1
    s_branch L_kloop
L_k_b3:
    s_lshl_b32 s58, s3, 8
    v_add_u32 v86, s58, v76
    v_mov_b32 v87, 128
    s_mul_i32 s58, s54, 384
    s_add_u32 s58, s58, 896
    s_add_u32 s58, s58, s52
    s_lshl_b32 s60, s3, 7
    s_add_u32 s60, s60, s58
    s_mul_i32 s61, s7, 4728
    s_sub_u32 s61, s52, s61
    s_lshl_b32 s58, s54, 6
    s_add_u32 s61, s61, s58
    s_waitcnt lgkmcnt(0)
    s_barrier
    ds_read_b128 v[36:39], v87
    ds_read_b128 v[40:43], v87 offset:16
    ds_read_b32 v44, v86 offset:1024
    ds_read_b32 v45, v86 offset:1792
    ds_read_b32 v46, v86 offset:2560
    ds_read_b32 v47, v86 offset:3328
    s_waitcnt lgkmcnt(0)
    v_max3_f32 v48, v36, v38, v40
    v_max_f32 v48, v48, v42
    v_sub_f32 v36, v36, v48
    v_sub_f32 v38, v38, v48
    v_sub_f32 v40, v40, v48
    v_sub_f32 v42, v42, v48
    v_exp_f32 v36, v36
    v_exp_f32 v38, v38
    v_exp_f32 v40, v40
    v_exp_f32 v42, v42
    v_mul_f32 v49, v36, v37
    v_mul_f32 v83, v36, v44
    v_fmac_f32 v49, v38, v39
    v_fmac_f32 v83, v38, v45
    v_fmac_f32 v49, v40, v41
    v_fmac_f32 v83, v40, v46
    v_fmac_f32 v49, v42, v43
    v_fmac_f32 v83, v42, v47
    v_rcp_f32 v84, v49
    s_nop 0
    v_mul_f32 v83, v83, v84
    s_nop 1
    v_mov_b32_dpp v84, v83 row_ror:8 row_mask:0xf bank_mask:0xf
    v_cvt_pk_bf16_f32 v83, v83, v84
    s_mov_b64 exec, s[64:65]
    s_cmp_eq_u32 s55, 0
    s_cbranch_scc1 L_sl_42
    buffer_store_dword v83, v71, s[48:51], s60 offen
L_sd_43:
    s_cmp_lg_u32 s3, 1
    s_cbranch_scc1 L_z_41
    s_mov_b64 exec, 1
    s_cmp_eq_u32 s55, 0
    s_cbranch_scc1 L_sl_44
    buffer_store_dwordx2 v[48:49], v71, s[48:51], s61 offen offset:1664
L_sd_45:
L_z_41:
    s_mov_b64 exec, -1
    s_cmp_ge_u32 s5, 30
    s_cbranch_scc1 L_k_next
    s_cmp_lg_u32 s54, 0
    s_cbranch_scc1 L_k_nb3b
    s_barrier
    s_cmp_lg_u32 s3, 0
    s_cbranch_scc1 L_k_nb3b
    v_bfe_u32 v85, v0, 3, 1
    v_lshrrev_b32 v86, 5, v0
    v_lshl_add_u32 v85, v86, 1, v85
    v_bfe_u32 v86, v0, 4, 1
    v_lshl_add_u32 v85, v86, 3, v85
    v_and_b32 v86, 7, v0
    v_mul_u32_u24 v85, 1280, v85
    v_lshl_add_u32 v85, v86, 4, v85
    s_mul_i32 s58, s4, 192
    s_lshl_b32 s60, s57, 6
    s_add_u32 s61, s58, s60
    s_mul_i32 s58, s61, 1280
    s_lshl_b32 s60, s56, 7
    s_add_u32 s58, s58, s60
    buffer_load_dwordx4 v[224:227], v85, s[36:39], s58 offen nt
    s_add_u32 s58, s58, 5120
    buffer_load_dwordx4 v[228:231], v85, s[36:39], s58 offen nt
    s_add_u32 s58, s58, 15360
    buffer_load_dwordx4 v[232:235], v85, s[36:39], s58 offen nt
    s_add_u32 s58, s58, 5120
    buffer_load_dwordx4 v[236:239], v85, s[36:39], s58 offen nt
    s_add_u32 s58, s58, 15360
    buffer_load_dwordx4 v[240:243], v85, s[36:39], s58 offen nt
    s_add_u32 s58, s58, 5120
    buffer_load_dwordx4 v[244:247], v85, s[36:39], s58 offen nt
    s_add_u32 s58, s58, 15360
    buffer_load_dwordx4 v[248:251], v85, s[36:39], s58 offen nt
    s_add_u32 s58, s58, 5120
    buffer_load_dwordx4 v[252:255], v85, s[36:39], s58 offen nt
    v_bfe_u32 v85, v0, 3, 1
    v_lshl_add_u32 v85, v85, 1, v71
    s_lshl_b32 s61, s61, 1
    buffer_load_ushort v81, v85, s[32:35], s61 offen
L_k_nb3b:
    s_barrier
    s_cmp_eq_u32 s3, 0
    s_cbranch_scc1 L_p5
    s_cmp_lg_u32 s3, 1
    s_cbranch_scc1 L_k_b5
    s_mul_i32 s58, s54, 256
    s_add_u32 s58, s58, 1792
    s_add_u32 s58, s58, s52
    v_lshlrev_b32 v83, 7, v0
    s_mov_b64 exec, 3
    buffer_load_dword v36, v83, s[48:51], s58 offen sc1
    buffer_load_dword v37, v83, s[48:51], s52 offen offset:2304 sc1
    buffer_load_dword v38, v76, s[48:51], s52 offen offset:1664 sc1
    s_mov_b64 exec, -1
L_k_b5:
    s_barrier
    s_barrier
    s_branch L_k_next
L_p5:
    v_mov_b32 v20, 0
    v_mov_b32 v21, 0
    v_mov_b32 v22, 0
    v_mov_b32 v23, 0
    s_mul_i32 s62, s57, 47360
    s_add_u32 s62, s62, s53
    s_cmp_lg_u32 s54, 0
    s_cbranch_scc1 L_p5_nocs
    s_add_u32 s58, s62, 2304
    s_add_u32 s60, s58, 18944
    s_add_u32 s61, s58, 37888
    s_barrier
    v_mov_b32 v44, 0
    v_mov_b32 v45, 0
    v_mov_b32 v46, 0
    v_mov_b32 v47, 0
    v_mov_b32 v48, 0
    v_mov_b32 v49, 0
    s_mov_b32 s70, 0
L_poll_46:
    buffer_load_dwordx4 v[36:39], v73, s[48:51], s58 offen sc1
    buffer_load_dwordx4 v[40:43], v73, s[48:51], s60 offen sc1
    s_mov_b32 exec_hi, 0
    buffer_load_dwordx4 v[44:47], v73, s[48:51], s61 offen sc1
    s_mov_b64 exec, -1
    s_add_u32 s70, s70, 1
    s_cmp_lt_u32 s70, 200000
    s_cbranch_scc0 L_retry_47
.p2align 3
    s_nop 0
    s_waitcnt vmcnt(0)
    v_max3_u32 v3, v36, v37, v38
    v_max3_u32 v3, v3, v39, v40
    v_max3_u32 v3, v3, v41, v42
    v_max3_u32 v3, v3, v43, v44
    v_max3_u32 v3, v3, v45, v46
    v_max_u32 v3, v3, v47
    v_cmp_eq_u32 vcc, -1, v3
    s_cbranch_vccnz L_poll_46
L_got_48:
    v_add_f32 v52, v36, v40
    v_add_f32 v53, v37, v41
    v_add_f32 v54, v38, v42
    v_add_f32 v55, v39, v43
    v_add_f32 v52, v52, v44
    v_add_f32 v53, v53, v45
    v_add_f32 v54, v54, v46
    v_add_f32 v55, v55, v47
    s_nop 0
    v_permlane32_swap_b32 v52, v54
    v_permlane32_swap_b32 v53, v55
    v_add_f32 v52, v52, v54
    v_add_f32 v53, v53, v55
    s_nop 1
    v_permlane16_swap_b32 v52, v53
    v_add_f32 v82, v52, v53
    v_lshlrev_b32 v81, 16, v81
    s_branch L_p5_g
L_p5_nocs:
    s_barrier
    s_sleep 7
L_p5_g:
    s_mul_i32 s71, s54, 128
    s_add_u32 s71, s71, 256
    s_add_u32 s71, s71, s52
    s_mul_i32 s58, s54, 256
    s_add_u32 s58, s58, 1792
    s_add_u32 s58, s58, s62
    s_add_u32 s60, s58, 18944
    s_add_u32 s61, s58, 37888
    s_mul_i32 s63, s54, 3
    s_add_u32 s63, s63, s57
    s_add_u32 s63, s63, 1
    s_mul_i32 s63, s63, 4736
    s_add_u32 s63, s63, s53
    v_mov_b32 v44, 0
    v_mov_b32 v45, 0
    v_mov_b32 v46, 0
    v_mov_b32 v47, 0
    v_mov_b32 v48, 0
    v_mov_b32 v49, 0
    s_mov_b32 s70, 0
    buffer_load_dwordx4 v[36:39], v73, s[48:51], s58 offen sc1
    buffer_load_dwordx4 v[40:43], v73, s[48:51], s60 offen sc1
    s_mov_b32 exec_hi, 0
    buffer_load_dwordx4 v[44:47], v73, s[48:51], s61 offen sc1
    s_mov_b64 exec, s[44:45]
    buffer_load_dwordx2 v[48:49], v69, s[48:51], s63 offen offset:1664 sc1
    s_mov_b64 exec, -1
    s_nop 12
    s_nop 12
L_poll_49:
    buffer_load_dwordx4 v[36:39], v73, s[48:51], s58 offen sc1
    buffer_load_dwordx4 v[40:43], v73, s[48:51], s60 offen sc1
    s_mov_b32 exec_hi, 0
    buffer_load_dwordx4 v[44:47], v73, s[48:51], s61 offen sc1
    s_mov_b64 exec, s[44:45]
    buffer_load_dwordx2 v[48:49], v69, s[48:51], s63 offen offset:1664 sc1
    s_mov_b64 exec, -1
    s_add_u32 s70, s70, 1
    s_cmp_lt_u32 s70, 200000
    s_cbranch_scc0 L_retry_50
.p2align 3
    s_nop 0
    s_waitcnt vmcnt(4)
    v_max3_u32 v3, v36, v37, v38
    v_max3_u32 v3, v3, v39, v40
    v_max3_u32 v3, v3, v41, v42
    v_max3_u32 v3, v3, v43, v44
    v_max3_u32 v3, v3, v45, v46
    v_max3_u32 v3, v3, v47, v48
    v_max_u32 v3, v3, v49
    v_cmp_eq_u32 vcc, -1, v3
    s_cbranch_vccnz L_poll_49
L_got_51:
    v_add_f32_dpp v50, v48, v48 quad_perm:[1,0,3,2] row_mask:0xf bank_mask:0xf
    v_add_f32 v52, v36, v40
    v_add_f32_dpp v51, v49, v49 quad_perm:[1,0,3,2] row_mask:0xf bank_mask:0xf
    v_add_f32 v53, v37, v41
    v_add_f32_dpp v50, v50, v50 quad_perm:[2,3,0,1] row_mask:0xf bank_mask:0xf
    v_add_f32 v54, v38, v42
    v_add_f32_dpp v51, v51, v51 quad_perm:[2,3,0,1] row_mask:0xf bank_mask:0xf
    v_add_f32 v55, v39, v43
    v_add_f32_dpp v50, v50, v50 row_half_mirror row_mask:0xf bank_mask:0xf
    v_add_f32 v52, v52, v44
    v_add_f32_dpp v51, v51, v51 row_half_mirror row_mask:0xf bank_mask:0xf
    v_add_f32 v53, v53, v45
    v_add_f32_dpp v50, v50, v50 row_mirror row_mask:0xf bank_mask:0xf
    v_add_f32 v54, v54, v46
    v_add_f32_dpp v51, v51, v51 row_mirror row_mask:0xf bank_mask:0xf
    v_add_f32 v55, v55, v47
    v_mul_f32 v50, 0x3acccccd, v50
    v_permlane32_swap_b32 v52, v54
    v_mul_f32 v51, 0x3acccccd, v51
    v_permlane32_swap_b32 v53, v55
    v_fma_f32 v51, -v50, v50, v51
    v_add_f32 v52, v52, v54
    v_max_f32 v51, 0, v51
    v_add_f32 v53, v53, v55
    v_add_f32 v51, 0x3727c5ac, v51
    s_nop 0
    v_permlane16_swap_b32 v52, v53
    v_rsq_f32 v51, v51
    v_add_f32 v83, v52, v53
    v_fma_f32 v83, -v50, v82, v83
    v_fma_f32 v83, v83, v51, v81
    v_mul_f32 v84, 0x3fb8aa3b, v83
    v_exp_f32 v84, -|v84|
    v_cmp_gt_f32 vcc, 0, v83
    v_mov_b32 v87, 2.0
    v_fma_f32 v85, v84, 2.0, 1.0
    v_add_f32 v86, 2.0, v84
    v_mul_f32 v86, v86, v84
    v_mul_f32 v84, v84, v84
    v_add_f32 v84, v84, v84
    v_cndmask_b32 v85, v85, v86, vcc
    v_cndmask_b32 v84, v84, v87, vcc
    v_add_f32 v86, v85, v84
    v_rcp_f32 v86, v86
    v_mul_f32 v85, v85, v83
    v_mul_f32 v85, v85, v86
    s_nop 1
    v_mov_b32_dpp v84, v85 row_ror:8 row_mask:0xf bank_mask:0xf
    v_cvt_pk_bf16_f32 v87, v85, v84
.p2align 3
    s_nop 1
    v_and_b32_dpp v12, v87, v56 row_newbcast:0 row_mask:0xf bank_mask:0xf
    v_and_b32_dpp v13, v87, v57 row_newbcast:0 row_mask:0xf bank_mask:0xf
    v_and_b32_dpp v14, v87, v56 row_newbcast:1 row_mask:0xf bank_mask:0xf
    v_and_b32_dpp v15, v87, v57 row_newbcast:1 row_mask:0xf bank_mask:0xf
    v_and_b32_dpp v16, v87, v56 row_newbcast:2 row_mask:0xf bank_mask:0xf
    v_and_b32_dpp v17, v87, v57 row_newbcast:2 row_mask:0xf bank_mask:0xf
    v_smfmac_f32_16x16x64_bf16 v[20:23], v[12:15], v[224:231], v58
    v_and_b32_dpp v18, v87, v56 row_newbcast:3 row_mask:0xf bank_mask:0xf
    v_and_b32_dpp v19, v87, v57 row_newbcast:3 row_mask:0xf bank_mask:0xf
    v_and_b32_dpp v12, v87, v56 row_newbcast:4 row_mask:0xf bank_mask:0xf
    v_and_b32_dpp v13, v87, v57 row_newbcast:4 row_mask:0xf bank_mask:0xf
    v_smfmac_f32_16x16x64_bf16 v[20:23], v[16:19], v[232:239], v58
    v_and_b32_dpp v14, v87, v56 row_newbcast:5 row_mask:0xf bank_mask:0xf
    v_and_b32_dpp v15, v87, v57 row_newbcast:5 row_mask:0xf bank_mask:0xf
    v_and_b32_dpp v16, v87, v56 row_newbcast:6 row_mask:0xf bank_mask:0xf
    v_and_b32_dpp v17, v87, v57 row_newbcast:6 row_mask:0xf bank_mask:0xf
    v_smfmac_f32_16x16x64_bf16 v[20:23], v[12:15], v[240:247], v58
    v_and_b32_dpp v18, v87, v56 row_newbcast:7 row_mask:0xf bank_mask:0xf
    v_and_b32_dpp v19, v87, v57 row_newbcast:7 row_mask:0xf bank_mask:0xf
    s_nop 1
    v_smfmac_f32_16x16x64_bf16 v[20:23], v[16:19], v[248:255], v58
    s_nop 7
    v_add_f32_dpp v83, v21, v20 row_ror:8 row_mask:0xf bank_mask:0xf
    v_add_f32_dpp v84, v23, v22 row_ror:8 row_mask:0xf bank_mask:0xf
    s_mov_b64 exec, s[64:65]
    v_cvt_pk_bf16_f32 v83, v83, v84
    buffer_store_dword v83, v71, s[48:51], s71 offen sc1
    s_mov_b64 exec, -1
    s_barrier
L_k_next:
    s_cmp_lg_u32 s54, 0
    s_cbranch_scc1 L_final
    s_mov_b32 s54, 1
    s_cmp_lg_u32 s3, 2
    s_cbranch_scc1 L_kloop
    s_cmp_lg_u32 s2, 0
    s_cbranch_scc1 L_nogen
    s_mov_b64 exec, 1
    v_mov_b32 v83, s74
    v_mov_b32 v84, 1212416
    buffer_store_dword v83, v84, s[48:51], 0 offen sc1
    s_mov_b64 exec, -1
L_nogen:
    buffer_load_dword v40, v70, s[48:51], 0 offen offset:512 sc1
    buffer_load_dword v41, v70, s[48:51], 0 offen offset:640 sc1
    buffer_load_dword v42, v70, s[48:51], 0 offen offset:768 sc1
    s_branch L_kloop
L_final:
    s_cmp_lg_u32 s3, 3
    s_cbranch_scc1 L_fin2
    s_cmp_lg_u32 s4, 0
    s_cbranch_scc1 L_fin2
    s_cmp_ge_u32 s5, 10
    s_cbranch_scc1 L_fin2
    s_lshl_b32 s63, s5, 7
    s_mul_i32 s58, s56, 4736
    s_add_u32 s60, s58, 47360
    s_add_u32 s61, s58, 94720
    s_sleep 8
    s_mov_b32 s70, 0
L_poll_52:
    buffer_load_dwordx4 v[36:39], v72, s[48:51], s58 offen offset:384 sc1
    buffer_load_dwordx4 v[40:43], v72, s[48:51], s60 offen offset:384 sc1
    buffer_load_dwordx4 v[44:47], v72, s[48:51], s61 offen offset:384 sc1
    s_add_u32 s70, s70, 1
    s_cmp_lt_u32 s70, 200000
    s_cbranch_scc0 L_retry_53
.p2align 3
    s_nop 0
    s_waitcnt vmcnt(0)
    v_mfma_f32_16x16x32_bf16 v[20:23], v[4:7], v[36:39], v[64:67]
    v_max3_u32 v3, v36, v37, v38
    v_max3_u32 v3, v3, v39, v40
    v_mfma_f32_16x16x32_bf16 v[20:23], v[4:7], v[40:43], v[20:23]
    v_max3_u32 v3, v3, v41, v42
    v_max3_u32 v3, v3, v43, v44
    v_mfma_f32_16x16x32_bf16 v[20:23], v[4:7], v[44:47], v[20:23]
    v_max3_u32 v3, v3, v45, v46
    v_max_u32 v3, v3, v47
    v_cmp_eq_u32 vcc, -1, v3
    s_cbranch_vccnz L_poll_52
L_got_54:
    s_nop 3
    v_add_f32_dpp v85, v21, v20 row_ror:8 row_mask:0xf bank_mask:0xf
    v_add_f32_dpp v86, v23, v22 row_ror:8 row_mask:0xf bank_mask:0xf
    v_cvt_pk_bf16_f32 v87, v85, v86
    s_mov_b64 exec, s[64:65]
    buffer_store_dword v87, v71, s[40:43], s63 offen
    s_mov_b64 exec, -1
L_fin2:
    s_endpgm
L_vloop:
    buffer_load_dword v62, v70, s[48:51], 0 offen offset:1280 sc1
    s_cmp_eq_u32 s3, 7
    s_cbranch_scc1 L_v7_b1
    v_mov_b32 v36, 0
    v_mov_b32 v38, 0
    v_mov_b32 v39, 0
    s_add_u32 s58, s53, 33152
    v_mov_b32 v20, 0
    v_mov_b32 v21, 0
    v_mov_b32 v22, 0
    v_mov_b32 v23, 0
    s_sleep 26
    s_mov_b32 s70, 0
L_poll_55:
    s_mov_b64 exec, s[44:45]
    buffer_load_dword v36, v68, s[48:51], 0 offen offset:2560 sc1
    buffer_load_dwordx2 v[38:39], v69, s[48:51], s58 offen offset:1664 sc1
    s_mov_b64 exec, -1
    s_add_u32 s70, s70, 1
    s_cmp_lt_u32 s70, 200000
    s_cbranch_scc0 L_retry_56
.p2align 3
    s_nop 0
    s_waitcnt vmcnt(0)
    v_max3_u32 v3, v36, v38, v39
    v_cmp_eq_u32 vcc, -1, v3
    s_cbranch_vccnz L_poll_55
L_got_57:
    s_barrier
L_qproj:
.p2align 3
    v_and_b32_dpp v12, v36, v56 row_newbcast:0 row_mask:0xf bank_mask:0xf
    v_and_b32_dpp v13, v36, v57 row_newbcast:0 row_mask:0xf bank_mask:0xf
    v_add_f32_dpp v83, v38, v38 quad_perm:[1,0,3,2] row_mask:0xf bank_mask:0xf
    v_and_b32_dpp v14, v36, v56 row_newbcast:1 row_mask:0xf bank_mask:0xf
    v_and_b32_dpp v15, v36, v57 row_newbcast:1 row_mask:0xf bank_mask:0xf
    v_add_f32_dpp v84, v39, v39 quad_perm:[1,0,3,2] row_mask:0xf bank_mask:0xf
    v_and_b32_dpp v16, v36, v56 row_newbcast:2 row_mask:0xf bank_mask:0xf
    v_and_b32_dpp v17, v36, v57 row_newbcast:2 row_mask:0xf bank_mask:0xf
    v_smfmac_f32_16x16x64_bf16 v[20:23], v[12:15], v[184:191], v58
    v_add_f32_dpp v83, v83, v83 quad_perm:[2,3,0,1] row_mask:0xf bank_mask:0xf
    v_and_b32_dpp v18, v36, v56 row_newbcast:3 row_mask:0xf bank_mask:0xf
    v_and_b32_dpp v19, v36, v57 row_newbcast:3 row_mask:0xf bank_mask:0xf
    v_add_f32_dpp v84, v84, v84 quad_perm:[2,3,0,1] row_mask:0xf bank_mask:0xf
    v_and_b32_dpp v12, v36, v56 row_newbcast:4 row_mask:0xf bank_mask:0xf
    v_and_b32_dpp v13, v36, v57 row_newbcast:4 row_mask:0xf bank_mask:0xf
    v_smfmac_f32_16x16x64_bf16 v[20:23], v[16:19], v[192:199], v58
    v_add_f32_dpp v83, v83, v83 row_half_mirror row_mask:0xf bank_mask:0xf
    v_and_b32_dpp v14, v36, v56 row_newbcast:5 row_mask:0xf bank_mask:0xf
    v_and_b32_dpp v15, v36, v57 row_newbcast:5 row_mask:0xf bank_mask:0xf
    v_add_f32_dpp v84, v84, v84 row_half_mirror row_mask:0xf bank_mask:0xf
    v_and_b32_dpp v16, v36, v56 row_newbcast:6 row_mask:0xf bank_mask:0xf
    v_and_b32_dpp v17, v36, v57 row_newbcast:6 row_mask:0xf bank_mask:0xf
    v_smfmac_f32_16x16x64_bf16 v[20:23], v[12:15], v[200:207], v58
    v_add_f32_dpp v83, v83, v83 row_mirror row_mask:0xf bank_mask:0xf
    v_and_b32_dpp v18, v36, v56 row_newbcast:7 row_mask:0xf bank_mask:0xf
    v_and_b32_dpp v19, v36, v57 row_newbcast:7 row_mask:0xf bank_mask:0xf
    v_add_f32_dpp v84, v84, v84 row_mirror row_mask:0xf bank_mask:0xf
    v_and_b32_dpp v12, v36, v56 row_newbcast:8 row_mask:0xf bank_mask:0xf
    v_and_b32_dpp v13, v36, v57 row_newbcast:8 row_mask:0xf bank_mask:0xf
    v_smfmac_f32_16x16x64_bf16 v[20:23], v[16:19], v[208:215], v58
    v_mul_f32 v83, 0x3acccccd, v83
    v_and_b32_dpp v14, v36, v56 row_newbcast:9 row_mask:0xf bank_mask:0xf
    v_and_b32_dpp v15, v36, v57 row_newbcast:9 row_mask:0xf bank_mask:0xf
    v_mul_f32 v84, 0x3acccccd, v84
    v_fma_f32 v84, -v83, v83, v84
    v_max_f32 v84, 0, v84
    v_smfmac_f32_16x16x64_bf16 v[20:23], v[12:15], v[216:223], v58
    v_add_f32 v84, 0x3727c5ac, v84
    v_rsq_f32 v84, v84
    s_nop 5
    v_add_f32_dpp v85, v21, v20 row_ror:8 row_mask:0xf bank_mask:0xf
    v_add_f32_dpp v86, v23, v22 row_ror:8 row_mask:0xf bank_mask:0xf
    v_fma_f32 v85, -v83, v77, v85
    v_fma_f32 v86, -v83, v78, v86
    v_mul_f32 v85, v85, v84
    v_mul_f32 v86, v86, v84
    v_cvt_pk_bf16_f32 v87, v85, v86
    s_cmp_eq_u32 s54, 0
    s_cbranch_scc1 L_qp_ret0
    s_mov_b64 exec, s[64:65]
    s_cmp_eq_u32 s55, 0
    s_cbranch_scc1 L_sl_58
    buffer_store_dword v87, v74, s[48:51], 0 offen offset:512
L_sd_59:
    s_mov_b64 exec, -1
    s_branch L_v_b2
L_v7_b1:
    s_barrier
L_v_b2:
    s_and_b32 s58, s3, 3
    s_mul_i32 s58, s58, 768
    v_add_u32 v86, s58, v76
    v_mov_b32 v20, 0
    v_mov_b32 v21, 0
    v_mov_b32 v22, 0
    v_mov_b32 v23, 0
    v_mov_b32 v24, 0
    v_mov_b32 v25, 0
    v_mov_b32 v26, 0
    v_mov_b32 v27, 0
    v_mov_b32 v28, 0
    v_mov_b32 v29, 0
    v_mov_b32 v30, 0
    v_mov_b32 v31, 0
    s_cmp_eq_u32 s54, 0
    s_cbranch_scc1 L_v_b2a
    s_waitcnt vmcnt(0)
L_v_b2a:
    s_barrier
    ds_read_b128 v[36:39], v75
    ds_read_b128 v[40:43], v75 offset:16
    s_cmp_eq_u32 s54, 0
    s_cbranch_scc1 L_v_wo
L_v_nowo:
    s_waitcnt lgkmcnt(0)
.p2align 3
    v_and_b32 v12, v36, v56
    v_and_b32 v13, v36, v57
    v_and_b32 v14, v37, v56
    v_and_b32 v15, v37, v57
    s_waitcnt vmcnt(26)
    s_nop 0
    v_smfmac_f32_16x16x64_bf16 v[20:23], v[12:15], v[88:95], v58
    v_and_b32 v16, v38, v56
    v_and_b32 v17, v38, v57
    v_smfmac_f32_16x16x64_bf16 v[24:27], v[12:15], v[96:103], v58
    v_and_b32 v18, v39, v56
    v_and_b32 v19, v39, v57
    v_smfmac_f32_16x16x64_bf16 v[28:31], v[12:15], v[104:111], v58
    s_waitcnt vmcnt(20)
    v_smfmac_f32_16x16x64_bf16 v[20:23], v[16:19], v[112:119], v58
    v_and_b32 v12, v40, v56
    v_and_b32 v13, v40, v57
    v_smfmac_f32_16x16x64_bf16 v[24:27], v[16:19], v[120:127], v58
    v_and_b32 v14, v41, v56
    v_and_b32 v15, v41, v57
    v_smfmac_f32_16x16x64_bf16 v[28:31], v[16:19], v[128:135], v58
    s_waitcnt vmcnt(14)
    v_smfmac_f32_16x16x64_bf16 v[20:23], v[12:15], v[136:143], v58
    v_and_b32 v16, v42, v56
    v_and_b32 v17, v42, v57
    v_smfmac_f32_16x16x64_bf16 v[24:27], v[12:15], v[144:151], v58
    v_and_b32 v18, v43, v56
    v_and_b32 v19, v43, v57
    v_smfmac_f32_16x16x64_bf16 v[28:31], v[12:15], v[152:159], v58
    s_waitcnt vmcnt(8)
    v_smfmac_f32_16x16x64_bf16 v[20:23], v[16:19], v[160:167], v58
    v_smfmac_f32_16x16x64_bf16 v[24:27], v[16:19], v[168:175], v58
    v_smfmac_f32_16x16x64_bf16 v[28:31], v[16:19], v[176:183], v58
    s_nop 5
    v_add_f32_dpp v83, v21, v20 row_ror:8 row_mask:0xf bank_mask:0x3
    v_add_f32_dpp v83, v22, v23 row_ror:8 row_mask:0xf bank_mask:0xc
    ds_write_b32 v86, v83 offset:1024
    v_add_f32_dpp v84, v25, v24 row_ror:8 row_mask:0xf bank_mask:0x3
    v_add_f32_dpp v84, v26, v27 row_ror:8 row_mask:0xf bank_mask:0xc
    ds_write_b32 v86, v84 offset:1280
    v_add_f32_dpp v85, v29, v28 row_ror:8 row_mask:0xf bank_mask:0x3
    v_add_f32_dpp v85, v30, v31 row_ror:8 row_mask:0xf bank_mask:0xc
    ds_write_b32 v86, v85 offset:1536
    s_mul_i32 s58, s54, 384
    s_add_u32 s58, s58, 896
    s_lshl_b32 s60, s54, 6
    s_waitcnt lgkmcnt(0)
    s_barrier
    s_cmp_ge_u32 s5, 30
    s_cbranch_scc1 L_v_next
    v_mov_b32 v24, 0
    v_mov_b32 v25, 0
    v_mov_b32 v26, 0
    v_mov_b32 v27, 0
    s_sleep 8
    s_mov_b32 s70, 0
    buffer_load_dwordx4 v[36:39], v70, s[48:51], s58 offen sc1
    buffer_load_dwordx2 v[40:41], v73, s[48:51], s60 offen offset:1664 sc1
    s_nop 12
    s_nop 12
L_poll_60:
    buffer_load_dwordx4 v[36:39], v70, s[48:51], s58 offen sc1
    buffer_load_dwordx2 v[40:41], v73, s[48:51], s60 offen offset:1664 sc1
    s_add_u32 s70, s70, 1
    s_cmp_lt_u32 s70, 200000
    s_cbranch_scc0 L_retry_61
.p2align 3
    s_nop 0
    s_waitcnt vmcnt(2)
    v_max3_u32 v3, v36, v37, v38
    v_max3_u32 v3, v3, v39, v40
    v_max_u32 v3, v3, v41
    v_cmp_eq_u32 vcc, -1, v3
    s_cbranch_vccnz L_poll_60
L_got_62:
    v_max_f32_dpp v83, v40, v40 quad_perm:[1,0,3,2] row_mask:0xf bank_mask:0xf
    s_nop 1
    v_max_f32_dpp v83, v83, v83 quad_perm:[2,3,0,1] row_mask:0xf bank_mask:0xf
    s_nop 1
    v_max_f32_dpp v83, v83, v83 row_half_mirror row_mask:0xf bank_mask:0xf
    s_cmp_lg_u32 s54, 0
    s_cbranch_scc1 L_v_nb3b
    s_barrier
L_v_nb3b:
    v_sub_f32 v84, v40, v83
    v_exp_f32 v84, v84
    s_nop 0
    v_mul_f32 v84, v84, v41
    s_nop 1
    v_mov_b32_dpp v85, v84 row_newbcast:0 row_mask:0xf bank_mask:0xf
    v_mov_b32_dpp v86, v84 row_newbcast:1 row_mask:0xf bank_mask:0xf
    v_cvt_pk_bf16_f32 v85, v85, v86
    v_perm_b32 v12, v85, v85, v8
    v_perm_b32 v13, v85, v85, v9
    v_perm_b32 v14, v85, v85, v10
    v_perm_b32 v15, v85, v85, v11
    v_cvt_pk_bf16_f32 v84, v84, v84
    v_lshlrev_b32 v84, 16, v84
    v_mfma_f32_16x16x32_bf16 v[20:23], v[12:15], v[36:39], 0
    s_nop 0
    v_add_f32_dpp v84, v84, v84 quad_perm:[1,0,3,2] row_mask:0xf bank_mask:0xf
    s_nop 1
    v_add_f32_dpp v84, v84, v84 quad_perm:[2,3,0,1] row_mask:0xf bank_mask:0xf
    s_nop 1
    v_add_f32_dpp v84, v84, v84 row_half_mirror row_mask:0xf bank_mask:0xf
    v_rcp_f32 v84, v84
    v_add_f32_dpp v85, v21, v20 row_ror:8 row_mask:0xf bank_mask:0xf
    v_add_f32_dpp v86, v23, v22 row_ror:8 row_mask:0xf bank_mask:0xf
    v_mul_f32 v85, v85, v84
    v_mul_f32 v86, v86, v84
    v_cvt_pk_bf16_f32 v87, v85, v86
.p2align 3
    s_nop 1
    v_and_b32_dpp v12, v87, v56 row_newbcast:0 row_mask:0xf bank_mask:0xf
    v_and_b32_dpp v13, v87, v57 row_newbcast:0 row_mask:0xf bank_mask:0xf
    v_and_b32_dpp v14, v87, v56 row_newbcast:1 row_mask:0xf bank_mask:0xf
    v_and_b32_dpp v15, v87, v57 row_newbcast:1 row_mask:0xf bank_mask:0xf
    v_and_b32_dpp v16, v87, v56 row_newbcast:2 row_mask:0xf bank_mask:0xf
    v_and_b32_dpp v17, v87, v57 row_newbcast:2 row_mask:0xf bank_mask:0xf
    v_smfmac_f32_16x16x64_bf16 v[24:27], v[12:15], v[224:231], v58
    v_and_b32_dpp v18, v87, v56 row_newbcast:3 row_mask:0xf bank_mask:0xf
    v_and_b32_dpp v19, v87, v57 row_newbcast:3 row_mask:0xf bank_mask:0xf
    v_and_b32_dpp v12, v87, v56 row_newbcast:4 row_mask:0xf bank_mask:0xf
    v_and_b32_dpp v13, v87, v57 row_newbcast:4 row_mask:0xf bank_mask:0xf
    v_smfmac_f32_16x16x64_bf16 v[24:27], v[16:19], v[232:239], v58
    v_and_b32_dpp v14, v87, v56 row_newbcast:5 row_mask:0xf bank_mask:0xf
    v_and_b32_dpp v15, v87, v57 row_newbcast:5 row_mask:0xf bank_mask:0xf
    v_and_b32_dpp v16, v87, v56 row_newbcast:6 row_mask:0xf bank_mask:0xf
    v_and_b32_dpp v17, v87, v57 row_newbcast:6 row_mask:0xf bank_mask:0xf
    v_smfmac_f32_16x16x64_bf16 v[24:27], v[12:15], v[240:247], v58
    v_and_b32_dpp v18, v87, v56 row_newbcast:7 row_mask:0xf bank_mask:0xf
    v_and_b32_dpp v19, v87, v57 row_newbcast:7 row_mask:0xf bank_mask:0xf
    s_nop 1
    v_smfmac_f32_16x16x64_bf16 v[24:27], v[16:19], v[248:255], v58
    s_mul_i32 s58, s54, 128
    s_add_u32 s58, s58, s52
    s_nop 5
    v_add_f32_dpp v83, v25, v24 row_ror:8 row_mask:0xf bank_mask:0x3
    v_add_f32_dpp v83, v26, v27 row_ror:8 row_mask:0xf bank_mask:0xc
    ds_write_b32 v80, v83 offset:4096
    s_waitcnt vmcnt(0) lgkmcnt(0)
    s_barrier
    s_cmp_lg_u32 s3, 7
    s_cbranch_scc1 L_v_b5
    ds_read_b32 v36, v76 offset:4096
    ds_read_b32 v37, v76 offset:4352
    ds_read_b32 v38, v76 offset:4608
    ds_read_b32 v39, v76 offset:4864
    s_waitcnt lgkmcnt(0)
    v_add_f32 v36, v36, v37
    v_add_f32 v38, v38, v39
    v_add_f32 v83, v36, v38
    s_nop 1
    v_mov_b32_dpp v84, v83 row_ror:8 row_mask:0xf bank_mask:0xf
    v_cvt_pk_bf16_f32 v83, v83, v84
    s_mov_b64 exec, s[64:65]
    buffer_store_dword v83, v71, s[48:51], s58 offen sc1
    s_mov_b64 exec, -1
L_v_b5:
    s_cmp_lg_u32 s54, 0
    s_cbranch_scc1 L_v_b5b
    s_and_b32 s58, s3, 3
    s_min_u32 s58, s58, 2
    s_mul_i32 s58, s58, 10752
    s_add_u32 s58, s58, 106496
    v_lshlrev_b32 v83, 4, v0
    v_add_u32 v83, s58, v83
    ds_read_b128 v[184:187], v83 offset:0
    ds_read_b128 v[188:191], v83 offset:1024
    ds_read_b128 v[192:195], v83 offset:2048
    ds_read_b128 v[196:199], v83 offset:3072
    ds_read_b128 v[200:203], v83 offset:4096
    ds_read_b128 v[204:207], v83 offset:5120
    ds_read_b128 v[208:211], v83 offset:6144
    ds_read_b128 v[212:215], v83 offset:7168
    ds_read_b128 v[216:219], v83 offset:8192
    ds_read_b128 v[220:223], v83 offset:9216
    v_add_u32 v84, s58, v76
    ds_read_b32 v77, v84 offset:10240
    ds_read_b32 v78, v84 offset:10496
    v_mov_b32 v85, 4
    ds_read_b32 v85, v85
    s_waitcnt lgkmcnt(0)
    v_readfirstlane_b32 s55, v85
    s_nop 0
    s_lshr_b32 s55, s55, 1
    s_add_u32 s58, s53, 33152
    buffer_load_dword v63, v68, s[48:51], 0 offen offset:2560 sc1
    buffer_load_dword v64, v69, s[48:51], s58 offen offset:1664 sc1
L_v_b5b:
    s_barrier
    s_barrier
    s_cmp_lg_u32 s54, 0
    s_cbranch_scc1 L_fin2
    s_mov_b32 s54, 1
    s_branch L_vloop
L_v_wo:
    v_bfe_u32 v60, v0, 3, 1
    v_lshrrev_b32 v61, 5, v0
    v_lshl_add_u32 v60, v61, 1, v60
    v_bfe_u32 v61, v0, 4, 1
    v_lshl_add_u32 v60, v61, 3, v60
    v_mul_u32_u24 v60, 1280, v60
    v_and_b32 v61, 7, v0
    v_lshl_add_u32 v60, v61, 4, v60
    s_min_u32 s62, s57, 2
    s_mul_i32 s58, s4, 768
    s_lshl_b32 s60, s62, 8
    s_add_u32 s58, s58, s60
    s_and_b32 s60, s3, 3
    s_lshl_b32 s60, s60, 6
    s_add_u32 s58, s58, s60
    s_mul_i32 s58, s58, 1280
    s_lshl_b32 s60, s56, 7
    s_add_u32 s58, s58, s60
    s_cmp_ge_u32 s5, 30
    s_cselect_b32 s58, 0x7f000000, s58
    buffer_load_dwordx4 v[224:227], v60, s[24:27], s58 offen nt
    s_add_u32 s58, s58, 5120
    buffer_load_dwordx4 v[228:231], v60, s[24:27], s58 offen nt
    s_add_u32 s58, s58, 15360
    buffer_load_dwordx4 v[232:235], v60, s[24:27], s58 offen nt
    s_add_u32 s58, s58, 5120
    buffer_load_dwordx4 v[236:239], v60, s[24:27], s58 offen nt
    s_add_u32 s58, s58, 15360
    buffer_load_dwordx4 v[240:243], v60, s[24:27], s58 offen nt
    s_add_u32 s58, s58, 5120
    buffer_load_dwordx4 v[244:247], v60, s[24:27], s58 offen nt
    s_add_u32 s58, s58, 15360
    buffer_load_dwordx4 v[248:251], v60, s[24:27], s58 offen nt
    s_add_u32 s58, s58, 5120
    buffer_load_dwordx4 v[252:255], v60, s[24:27], s58 offen nt
    s_mov_b32 s63, s58
    s_branch L_v_nowo
L_v_next:
    s_cmp_lg_u32 s54, 0
    s_cbranch_scc1 L_fin2
    s_and_b32 s58, s3, 3
    s_min_u32 s58, s58, 2
    s_mul_i32 s58, s58, 10752
    s_add_u32 s58, s58, 106496
    v_lshlrev_b32 v83, 4, v0
    v_add_u32 v83, s58, v83
    ds_read_b128 v[184:187], v83 offset:0
    ds_read_b128 v[188:191], v83 offset:1024
    ds_read_b128 v[192:195], v83 offset:2048
    ds_read_b128 v[196:199], v83 offset:3072
    ds_read_b128 v[200:203], v83 offset:4096
    ds_read_b128 v[204:207], v83 offset:5120
    ds_read_b128 v[208:211], v83 offset:6144
    ds_read_b128 v[212:215], v83 offset:7168
    ds_read_b128 v[216:219], v83 offset:8192
    ds_read_b128 v[220:223], v83 offset:9216
    v_add_u32 v84, s58, v76
    ds_read_b32 v77, v84 offset:10240
    ds_read_b32 v78, v84 offset:10496
    v_mov_b32 v85, 4
    ds_read_b32 v85, v85
    s_waitcnt lgkmcnt(0)
    v_readfirstlane_b32 s55, v85
    s_nop 0
    s_lshr_b32 s55, s55, 1
    s_add_u32 s58, s53, 33152
    buffer_load_dword v63, v68, s[48:51], 0 offen offset:2560 sc1
    buffer_load_dword v64, v69, s[48:51], s58 offen offset:1664 sc1
    s_mov_b32 s54, 1
    s_sleep 48
    s_branch L_vloop
L_retry_19:
    s_waitcnt vmcnt(0)
    s_branch L_got_20
L_sl_21:
    s_nop 7
    buffer_store_dword v87, v68, s[48:51], 0 offen offset:2560 sc1
    s_nop 1
    s_branch L_sd_22
L_sl_23:
    s_nop 7
    buffer_store_dword v83, v80, s[48:51], s63 offen offset:1664 sc1
    s_nop 1
    s_branch L_sd_24
L_retry_26:
    s_waitcnt vmcnt(0)
    s_branch L_got_27
L_retry_32:
    s_waitcnt vmcnt(0)
    s_branch L_got_33
L_sl_34:
    s_nop 7
    buffer_store_dword v77, v74, s[48:51], s52 offen offset:2304 sc1
    s_nop 1
    s_branch L_sd_35
L_retry_37:
    s_waitcnt vmcnt(0)
    s_branch L_got_38
L_sl_39:
    s_nop 7
    buffer_store_dword v86, v74, s[48:51], s62 offen sc1
    s_mov_b64 exec, s[46:47]
    buffer_store_dword v83, v80, s[48:51], s63 offen offset:1664 sc1
    s_nop 1
    s_branch L_sd_40
L_sl_42:
    s_nop 7
    buffer_store_dword v83, v71, s[48:51], s60 offen sc1
    s_nop 1
    s_branch L_sd_43
L_sl_44:
    s_nop 7
    buffer_store_dwordx2 v[48:49], v71, s[48:51], s61 offen offset:1664 sc1
    s_nop 1
    s_branch L_sd_45
L_retry_47:
    s_waitcnt vmcnt(0)
    s_branch L_got_48
L_retry_50:
    s_waitcnt vmcnt(0)
    s_branch L_got_51
L_retry_53:
    s_waitcnt vmcnt(0)
    s_branch L_got_54
L_retry_56:
    s_waitcnt vmcnt(0)
    s_branch L_got_57
L_sl_58:
    s_nop 7
    buffer_store_dword v87, v74, s[48:51], 0 offen offset:512 sc1
    s_nop 1
    s_branch L_sd_59
L_retry_61:
    s_waitcnt vmcnt(0)
    s_branch L_got_62
L_end:
    s_endpgm
.section .rodata,"a"
.p2align 6
.amdhsa_kernel interleave_layers__sliding_block_cached__dense_activation_mish__decode_kernel
.amdhsa_next_free_vgpr 256
.amdhsa_next_free_sgpr 102
.amdhsa_accum_offset 256
.amdhsa_group_segment_fixed_size 0
.amdhsa_kernarg_size 96
.amdhsa_user_sgpr_count 2
.amdhsa_user_sgpr_kernarg_segment_ptr 1
.amdhsa_system_sgpr_workgroup_id_x 1
.end_amdhsa_kernel
```
